```python
import torch

def _softmax(x, axis=-1):
    return torch.softmax(x, dim=axis)
def _gelu(x):
    return torch.nn.functional.gelu(x, approximate="tanh")
def _silu(x):
    return torch.nn.functional.silu(x)
def _sigmoid(x):
    return torch.sigmoid(x)
def _layernorm(x, axis=-1, eps=1e-5):
    m = x.mean(dim=axis, keepdim=True)
    v = x.var(dim=axis, keepdim=True, unbiased=False)
    return (x - m) / torch.sqrt(v + eps)
def _scatter_add(tgt, idx, src, axis=0):
    return tgt.clone().index_add_(axis, idx, src)
def _segment_sum(src, seg, n):
    out = torch.zeros((n,) + src.shape[1:], dtype=src.dtype)
    return out.index_add_(0, seg, src)
def _pad(x, pw):
    flat = tuple(v for pair in reversed(pw) for v in pair)
    return torch.nn.functional.pad(x, flat)

kernel_name = 'standalone__edge_featured_mpnn_mpnn__graph'

def setup_inputs():

    _w = (lambda a: (lambda t: t.to(torch.bfloat16) if t.is_floating_point() else t)(torch.as_tensor(a)))
    N, deg, D, De = 10000, 16, 128, max(16, 1)
    E = N * deg
    H = 2 * D
    return {
        "x": _w((lambda *s: torch.randn(*s, dtype=torch.bfloat16) * 0.05)(N, D)),
        "e_attr": _w((lambda *s: torch.randn(*s, dtype=torch.bfloat16) * 0.8)(E, De)),
        "src": _w((lambda lo, hi, *s: torch.randint(lo, hi, s))(0, N, E).to(torch.int64)),
        "dst": _w((lambda lo, hi, *s: torch.randint(lo, hi, s))(0, N, E).to(torch.int64)),
        "w1": _w((lambda *s: torch.randn(*s, dtype=torch.bfloat16) * 0.8)(2 * D + De, H) * (1.0 / (2 * D + De) ** 0.5)),
        "b1": _w((lambda *s: torch.randn(*s, dtype=torch.bfloat16) * 0.4)(H) * 0.01),
        "w2": _w((lambda *s: torch.randn(*s, dtype=torch.bfloat16) * 0.05)(H, D) * (1.0 / H ** 0.5)),
        "b2": _w((lambda *s: torch.randn(*s, dtype=torch.bfloat16) * 0.05)(D) * 0.01),
    }

def reference(x, e_attr, src, dst, w1, b1, w2, b2):
    N, D = x.shape
    h_src = x[src]
    h_dst = x[dst]
    m_in = torch.concatenate([h_src, h_dst, e_attr], axis=-1)
    h = _silu(m_in @ w1 + b1)
    msg = h @ w2 + b2
    return _segment_sum(msg, dst, N)
```

```asm
; @launch kernel=mpnn_prep_kernel grid=(224,1,1) block=(1024,1,1) lds=110000
; @launch kernel=standalone__edge_featured_mpnn_mpnn__graph_kernel grid=(256,1,1) block=(1024,1,1) lds=158464
.amdgcn_target "amdgcn-amd-amdhsa--gfx950"
.text
.globl mpnn_prep_kernel
.p2align 8
.type mpnn_prep_kernel,@function
mpnn_prep_kernel:
s_cmp_ge_u32 s2, 224
s_cbranch_scc1 K1_EXIT
s_load_dwordx16 s[4:19], s[0:1], 0
s_load_dwordx2 s[20:21], s[0:1], 64
s_load_dwordx2 s[24:25], s[0:1], 80
s_add_u32 s40, s2, 64
s_sub_u32 s41, s2, 157
s_cmp_lt_u32 s2, 157
s_cselect_b32 s40, s40, s41
s_cmp_lt_u32 s2, 221
s_cselect_b32 s2, s40, s2
v_and_b32 v1, 63, v0
v_lshrrev_b32 v2, 6, v0
s_nop 0
v_readfirstlane_b32 s3, v2
s_waitcnt lgkmcnt(0)
s_cmp_ge_u32 s2, 64
s_cbranch_scc1 K1_NOTSORT
s_mov_b32 s28, s10
s_mov_b32 s29, s11
s_mov_b32 s30, 0x9c400
s_mov_b32 s31, 0x20000
s_mov_b32 s32, s8
s_mov_b32 s33, s9
s_mov_b32 s34, 0x9c400
s_mov_b32 s35, 0x20000
s_mov_b32 s36, s24
s_mov_b32 s37, s25
s_mov_b32 s38, 0x200000
s_mov_b32 s39, 0x20000
s_mul_i32 s40, s2, 10000
v_lshlrev_b32 v3, 2, v0
v_add_u32 v3, s40, v3
s_movk_i32 s41, 0x1000
s_movk_i32 s42, 0x2000
buffer_load_dword v8, v3, s[28:31], 0 offen
buffer_load_dword v9, v3, s[28:31], s41 offen
buffer_load_dword v10, v3, s[28:31], s42 offen
buffer_load_dword v12, v3, s[32:35], 0 offen
buffer_load_dword v13, v3, s[32:35], s41 offen
buffer_load_dword v14, v3, s[32:35], s42 offen
v_and_b32 v4, 7, v0
v_cmp_eq_u32 vcc, 7, v4
v_mov_b32 v4, -1
v_mov_b32 v5, -1
v_mov_b32 v6, -1
v_mov_b32 v16, 0
v_cndmask_b32 v7, -1, v16, vcc
v_lshlrev_b32 v17, 4, v0
ds_write_b128 v17, v[4:7]
ds_write_b128 v17, v[4:7] offset:16384
v_lshlrev_b32 v18, 2, v0
ds_write_b32 v18, v16 offset:40960
s_waitcnt lgkmcnt(0)
s_barrier
s_waitcnt vmcnt(3)
v_mov_b32 v16, 1
v_and_b32 v20, 0xff, v8
v_lshlrev_b32 v28, 2, v20
ds_add_rtn_u32 v24, v28, v16 offset:40960
v_lshlrev_b32 v20, 7, v20
v_and_b32 v21, 0xff, v9
v_lshlrev_b32 v29, 2, v21
ds_add_rtn_u32 v25, v29, v16 offset:40960
v_lshlrev_b32 v21, 7, v21
v_and_b32 v22, 0xff, v10
v_cmp_gt_u32 vcc, 452, v0
v_mov_b32 v19, 0x100
v_cndmask_b32 v22, v19, v22, vcc
v_lshlrev_b32 v30, 2, v22
ds_add_rtn_u32 v26, v30, v16 offset:40960
v_lshlrev_b32 v22, 7, v22
s_waitcnt vmcnt(0)
v_mov_b32 v18, v0
v_lshrrev_b32 v19, 8, v8
v_lshl_or_b32 v8, v19, 12, v18
v_lshl_or_b32 v8, v12, 18, v8
v_add_u32 v18, 1024, v0
v_lshrrev_b32 v19, 8, v9
v_lshl_or_b32 v9, v19, 12, v18
v_lshl_or_b32 v9, v13, 18, v9
v_add_u32 v18, 2048, v0
v_lshrrev_b32 v19, 8, v10
v_lshl_or_b32 v10, v19, 12, v18
v_lshl_or_b32 v10, v14, 18, v10
v_mov_b32 v19, 0x8000
s_waitcnt lgkmcnt(0)
v_cmp_gt_u32 vcc, 31, v24
v_and_b32 v18, 15, v24
v_lshl_add_u32 v20, v18, 3, v20
v_lshrrev_b32 v18, 4, v24
v_lshl_add_u32 v20, v18, 2, v20
v_cndmask_b32 v20, v19, v20, vcc
ds_write_b32 v20, v8
v_cmp_gt_u32 vcc, 31, v25
v_and_b32 v18, 15, v25
v_lshl_add_u32 v21, v18, 3, v21
v_lshrrev_b32 v18, 4, v25
v_lshl_add_u32 v21, v18, 2, v21
v_cndmask_b32 v21, v19, v21, vcc
ds_write_b32 v21, v9
v_cmp_gt_u32 vcc, 31, v26
v_and_b32 v18, 15, v26
v_lshl_add_u32 v22, v18, 3, v22
v_lshrrev_b32 v18, 4, v26
v_lshl_add_u32 v22, v18, 2, v22
v_cndmask_b32 v22, v19, v22, vcc
ds_write_b32 v22, v10
v_lshrrev_b32 v18, 3, v0
v_lshlrev_b32 v18, 13, v18
v_and_b32 v19, 7, v0
v_lshl_add_u32 v18, v19, 4, v18
s_lshl_b32 s40, s2, 7
v_add_u32 v18, s40, v18
s_mov_b32 s41, 0x100000
s_waitcnt lgkmcnt(0)
s_barrier
v_lshrrev_b32 v19, 3, v0
v_lshlrev_b32 v19, 2, v19
ds_read_b32 v20, v19 offset:40960
ds_read_b32 v21, v19 offset:41472
ds_read_b128 v[4:7], v17
ds_read_b128 v[8:11], v17 offset:16384
v_and_b32 v19, 7, v0
v_cmp_eq_u32 vcc, 7, v19
s_waitcnt lgkmcnt(1)
v_cndmask_b32 v7, v7, v20, vcc
buffer_store_dwordx4 v[4:7], v18, s[36:39], 0 offen sc1
s_waitcnt lgkmcnt(0)
v_cndmask_b32 v11, v11, v21, vcc
buffer_store_dwordx4 v[8:11], v18, s[36:39], s41 offen sc1
s_endpgm
K1_NOTSORT:
s_cmp_eq_u32 s2, 223
s_cbranch_scc1 K1_TBLPREP
s_cmp_eq_u32 s2, 222
s_cbranch_scc1 K1_W2PREP
s_mov_b32 s32, s4
s_mov_b32 s33, s5
s_mov_b32 s34, 0x271000
s_mov_b32 s35, 0x20000
s_add_u32 s36, s24, 0x200000
s_addc_u32 s37, s25, 0
s_mov_b32 s38, 0x4e8000
s_mov_b32 s39, 0x20000
s_sub_u32 s47, s2, 64
s_cmp_eq_u32 s2, 221
s_cbranch_scc1 K1_NOX
v_lshrrev_b32 v8, 4, v1
v_and_b32 v9, 15, v1
v_xor_b32 v9, v9, v8
v_lshlrev_b32 v9, 4, v9
v_lshl_add_u32 v9, v8, 8, v9
s_lshl_b32 s48, s47, 14
s_lshl_b32 s49, s3, 10
s_add_u32 s48, s48, s49
v_add_u32 v9, s48, v9
s_mul_i32 s49, s3, 1088
s_add_u32 s49, s49, 73728
s_mov_b32 m0, s49
s_nop 0
buffer_load_dwordx4 v9, s[32:35], 0 offen lds
K1_NOX:
s_mov_b32 s28, s12
s_mov_b32 s29, s13
s_mov_b32 s30, 0x22000
s_mov_b32 s31, 0x20000
v_lshrrev_b32 v4, 5, v1
v_and_b32 v3, 31, v1
v_lshlrev_b32 v5, 2, v4
v_xor_b32 v3, v3, v5
v_lshlrev_b32 v3, 4, v3
v_lshl_add_u32 v3, v4, 9, v3
s_cmp_eq_u32 s2, 221
s_cselect_b32 s40, 0x10000, 0
s_lshl_b32 s41, s3, 12
s_add_u32 s40, s40, s41
s_mul_i32 s42, s3, 4608
s_add_u32 s43, s40, 0
s_add_u32 s44, s42, 0
s_mov_b32 m0, s44
s_nop 0
buffer_load_dwordx4 v3, s[28:31], s43 offen lds
s_add_u32 s43, s40, 1024
s_add_u32 s44, s42, 1152
s_mov_b32 m0, s44
s_nop 0
buffer_load_dwordx4 v3, s[28:31], s43 offen lds
s_add_u32 s43, s40, 2048
s_add_u32 s44, s42, 2304
s_mov_b32 m0, s44
s_nop 0
buffer_load_dwordx4 v3, s[28:31], s43 offen lds
s_add_u32 s43, s40, 3072
s_add_u32 s44, s42, 3456
s_mov_b32 m0, s44
s_nop 0
buffer_load_dwordx4 v3, s[28:31], s43 offen lds
v_bfe_u32 v5, v1, 2, 2
v_lshrrev_b32 v6, 1, v5
v_lshl_add_u32 v6, v4, 2, v6
v_mul_u32_u24 v6, 1152, v6
v_and_b32 v7, 1, v5
v_lshl_add_u32 v6, v7, 9, v6
s_and_b32 s45, s3, 7
v_xor_b32 v7, s45, v7
v_lshl_add_u32 v6, v7, 6, v6
v_bfe_u32 v7, v1, 4, 1
v_lshl_add_u32 v6, v7, 5, v6
v_and_b32 v7, 3, v1
v_lshl_add_u32 v6, v7, 3, v6
s_lshl_b32 s46, s45, 6
v_add_u32 v7, 36864, v6
s_cmp_eq_u32 s2, 221
s_cbranch_scc1 K1_W1BPREP
v_and_b32 v10, 31, v1
s_lshr_b32 s50, s3, 3
s_lshl_b32 s51, s50, 5
v_add_u32 v10, s51, v10
v_lshrrev_b32 v11, 2, v10
v_mul_u32_u24 v11, 1088, v11
v_and_b32 v12, 3, v10
v_lshl_add_u32 v11, v12, 8, v11
v_add_u32 v11, 73728, v11
v_xor_b32 v13, v4, v12
v_lshl_add_u32 v14, v13, 4, v11
v_xor_b32 v13, 2, v13
v_lshl_add_u32 v15, v13, 4, v11
s_mov_b32 s52, 0xbfb8aa3b
s_waitcnt vmcnt(0)
s_barrier
ds_read_b64_tr_b16 v[32:33], v6 offset:0
ds_read_b64_tr_b16 v[34:35], v6 offset:2304
ds_read_b128 v[64:67], v14 offset:0
ds_read_b64_tr_b16 v[36:37], v6 offset:9216
ds_read_b64_tr_b16 v[38:39], v6 offset:11520
ds_read_b128 v[68:71], v15 offset:0
ds_read_b64_tr_b16 v[40:41], v6 offset:18432
ds_read_b64_tr_b16 v[42:43], v6 offset:20736
ds_read_b128 v[72:75], v14 offset:64
ds_read_b64_tr_b16 v[44:45], v6 offset:27648
ds_read_b64_tr_b16 v[46:47], v6 offset:29952
ds_read_b128 v[76:79], v15 offset:64
ds_read_b64_tr_b16 v[48:49], v7 offset:0
ds_read_b64_tr_b16 v[50:51], v7 offset:2304
ds_read_b128 v[80:83], v14 offset:128
ds_read_b64_tr_b16 v[52:53], v7 offset:9216
ds_read_b64_tr_b16 v[54:55], v7 offset:11520
ds_read_b128 v[84:87], v15 offset:128
ds_read_b64_tr_b16 v[56:57], v7 offset:18432
ds_read_b64_tr_b16 v[58:59], v7 offset:20736
ds_read_b128 v[88:91], v14 offset:192
ds_read_b64_tr_b16 v[60:61], v7 offset:27648
ds_read_b64_tr_b16 v[62:63], v7 offset:29952
ds_read_b128 v[92:95], v15 offset:192
v_mul_u32_u24 v11, 528, v10
v_lshl_add_u32 v11, v4, 3, v11
v_add_u32 v11, s46, v11
s_waitcnt lgkmcnt(15)
v_mfma_f32_32x32x16_bf16 v[16:31], v[32:35], v[64:67], 0
s_waitcnt lgkmcnt(15)
v_mfma_f32_32x32x16_bf16 v[16:31], v[36:39], v[68:71], v[16:31]
s_waitcnt lgkmcnt(15)
v_mfma_f32_32x32x16_bf16 v[16:31], v[40:43], v[72:75], v[16:31]
s_waitcnt lgkmcnt(12)
v_mfma_f32_32x32x16_bf16 v[16:31], v[44:47], v[76:79], v[16:31]
s_waitcnt lgkmcnt(9)
v_mfma_f32_32x32x16_bf16 v[16:31], v[48:51], v[80:83], v[16:31]
s_waitcnt lgkmcnt(6)
v_mfma_f32_32x32x16_bf16 v[16:31], v[52:55], v[84:87], v[16:31]
s_waitcnt lgkmcnt(3)
v_mfma_f32_32x32x16_bf16 v[16:31], v[56:59], v[88:91], v[16:31]
s_waitcnt lgkmcnt(0)
v_mfma_f32_32x32x16_bf16 v[16:31], v[60:63], v[92:95], v[16:31]
s_barrier
v_and_b32 v12, 31, v1
s_lshl_b32 s53, s3, 2
v_add_u32 v13, s53, v4
v_mul_u32_u24 v14, 528, v13
v_lshl_add_u32 v14, v12, 4, v14
s_lshl_b32 s54, s47, 6
v_add_u32 v13, s54, v13
v_lshlrev_b32 v13, 9, v13
v_lshl_add_u32 v13, v12, 4, v13
s_nop 4
v_mul_f32 v16, s52, v16
v_mul_f32 v17, s52, v17
v_mul_f32 v18, s52, v18
v_mul_f32 v19, s52, v19
v_mul_f32 v20, s52, v20
v_mul_f32 v21, s52, v21
v_mul_f32 v22, s52, v22
v_mul_f32 v23, s52, v23
v_mul_f32 v24, s52, v24
v_mul_f32 v25, s52, v25
v_mul_f32 v26, s52, v26
v_mul_f32 v27, s52, v27
v_mul_f32 v28, s52, v28
v_mul_f32 v29, s52, v29
v_mul_f32 v30, s52, v30
v_mul_f32 v31, s52, v31
v_cvt_pk_bf16_f32 v32, v16, v17
v_cvt_pk_bf16_f32 v33, v18, v19
v_cvt_pk_bf16_f32 v34, v20, v21
v_cvt_pk_bf16_f32 v35, v22, v23
v_cvt_pk_bf16_f32 v36, v24, v25
v_cvt_pk_bf16_f32 v37, v26, v27
v_cvt_pk_bf16_f32 v38, v28, v29
v_cvt_pk_bf16_f32 v39, v30, v31
ds_write_b64 v11, v[32:33] offset:0
ds_write_b64 v11, v[34:35] offset:16
ds_write_b64 v11, v[36:37] offset:32
ds_write_b64 v11, v[38:39] offset:48
s_waitcnt lgkmcnt(0)
s_barrier
ds_read_b128 v[16:19], v14
ds_read_b128 v[20:23], v14 offset:1056
s_waitcnt lgkmcnt(1)
buffer_store_dwordx4 v[16:19], v13, s[36:39], 0 offen sc1
s_waitcnt lgkmcnt(0)
buffer_store_dwordx4 v[20:23], v13, s[36:39], 0 offen offset:1024 sc1
s_endpgm
K1_W1BPREP:
s_add_u32 s36, s24, 0x800000
s_addc_u32 s37, s25, 0
s_mov_b32 s38, 0x30000
s_mov_b32 s39, 0x20000
s_cmp_ge_u32 s3, 8
s_cbranch_scc1 K1_W1B_NOC
s_lshl_b32 s48, s3, 10
s_add_u32 s48, s48, 131072
s_mul_i32 s49, s3, 1152
s_add_u32 s49, s49, 73728
s_mov_b32 m0, s49
s_nop 0
buffer_load_dwordx4 v3, s[28:31], s48 offen lds
K1_W1B_NOC:
s_waitcnt vmcnt(0)
s_barrier
s_lshr_b32 s50, s3, 3
s_mul_i32 s51, s50, 36864
v_add_u32 v8, s51, v6
ds_read_b64_tr_b16 v[32:33], v8 offset:0
ds_read_b64_tr_b16 v[34:35], v8 offset:2304
ds_read_b64_tr_b16 v[36:37], v8 offset:9216
ds_read_b64_tr_b16 v[38:39], v8 offset:11520
ds_read_b64_tr_b16 v[40:41], v8 offset:18432
ds_read_b64_tr_b16 v[42:43], v8 offset:20736
ds_read_b64_tr_b16 v[44:45], v8 offset:27648
ds_read_b64_tr_b16 v[46:47], v8 offset:29952
v_lshlrev_b32 v3, 4, v1
s_lshl_b32 s52, s45, 13
s_lshl_b32 s53, s50, 12
s_add_u32 s52, s52, s53
v_add_u32 v9, s52, v3
s_waitcnt lgkmcnt(6)
buffer_store_dwordx4 v[32:35], v9, s[36:39], 0 offen offset:0 sc1
s_waitcnt lgkmcnt(4)
buffer_store_dwordx4 v[36:39], v9, s[36:39], 0 offen offset:1024 sc1
s_waitcnt lgkmcnt(2)
buffer_store_dwordx4 v[40:43], v9, s[36:39], 0 offen offset:2048 sc1
s_waitcnt lgkmcnt(0)
buffer_store_dwordx4 v[44:47], v9, s[36:39], 0 offen offset:3072 sc1
s_cmp_ge_u32 s3, 8
s_cbranch_scc1 K1_END
v_add_u32 v8, 73728, v6
ds_read_b64_tr_b16 v[48:49], v8 offset:0
ds_read_b64_tr_b16 v[50:51], v8 offset:2304
s_mov_b32 s52, 0xbfb8aa3b
s_waitcnt lgkmcnt(0)
v_lshlrev_b32 v52, 16, v48
v_and_b32 v53, 0xffff0000, v48
v_mul_f32 v52, s52, v52
v_mul_f32 v53, s52, v53
v_cvt_pk_bf16_f32 v56, v52, v53
v_lshlrev_b32 v52, 16, v49
v_and_b32 v53, 0xffff0000, v49
v_mul_f32 v52, s52, v52
v_mul_f32 v53, s52, v53
v_cvt_pk_bf16_f32 v57, v52, v53
v_lshlrev_b32 v52, 16, v50
v_and_b32 v53, 0xffff0000, v50
v_mul_f32 v52, s52, v52
v_mul_f32 v53, s52, v53
v_cvt_pk_bf16_f32 v58, v52, v53
v_lshlrev_b32 v52, 16, v51
v_and_b32 v53, 0xffff0000, v51
v_mul_f32 v52, s52, v52
v_mul_f32 v53, s52, v53
v_cvt_pk_bf16_f32 v59, v52, v53
s_lshl_b32 s52, s45, 10
s_add_u32 s52, s52, 65536
v_add_u32 v9, s52, v3
buffer_store_dwordx4 v[56:59], v9, s[36:39], 0 offen sc1
s_endpgm
K1_W2PREP:
s_mov_b32 s28, s16
s_mov_b32 s29, s17
s_mov_b32 s30, 0x10000
s_mov_b32 s31, 0x20000
s_add_u32 s36, s24, 0x800000
s_addc_u32 s37, s25, 0
s_mov_b32 s38, 0x30000
s_mov_b32 s39, 0x20000
v_lshrrev_b32 v4, 4, v1
v_and_b32 v3, 15, v1
v_lshlrev_b32 v5, 1, v4
v_xor_b32 v3, v3, v5
v_lshlrev_b32 v3, 4, v3
v_lshl_add_u32 v3, v4, 8, v3
s_lshl_b32 s40, s3, 12
s_mul_i32 s42, s3, 4352
s_add_u32 s43, s40, 0
s_add_u32 s44, s42, 0
s_mov_b32 m0, s44
s_nop 0
buffer_load_dwordx4 v3, s[28:31], s43 offen lds
s_add_u32 s43, s40, 1024
s_add_u32 s44, s42, 1088
s_mov_b32 m0, s44
s_nop 0
buffer_load_dwordx4 v3, s[28:31], s43 offen lds
s_add_u32 s43, s40, 2048
s_add_u32 s44, s42, 2176
s_mov_b32 m0, s44
s_nop 0
buffer_load_dwordx4 v3, s[28:31], s43 offen lds
s_add_u32 s43, s40, 3072
s_add_u32 s44, s42, 3264
s_mov_b32 m0, s44
s_nop 0
buffer_load_dwordx4 v3, s[28:31], s43 offen lds
v_lshrrev_b32 v4, 5, v1
v_mul_u32_u24 v6, 2176, v4
v_bfe_u32 v5, v1, 2, 2
v_lshl_add_u32 v6, v5, 8, v6
s_and_b32 s45, s3, 3
s_lshr_b32 s50, s3, 2
s_lshl_b32 s46, s45, 1
v_bfe_u32 v7, v1, 4, 1
v_add_u32 v7, s46, v7
v_xor_b32 v7, v7, v5
v_lshl_add_u32 v6, v7, 5, v6
v_and_b32 v7, 3, v1
v_lshl_add_u32 v6, v7, 3, v6
s_mul_i32 s51, s50, 17408
v_add_u32 v6, s51, v6
s_waitcnt vmcnt(0)
s_barrier
ds_read_b64_tr_b16 v[32:33], v6 offset:0
ds_read_b64_tr_b16 v[34:35], v6 offset:1088
ds_read_b64_tr_b16 v[36:37], v6 offset:4352
ds_read_b64_tr_b16 v[38:39], v6 offset:5440
ds_read_b64_tr_b16 v[40:41], v6 offset:8704
ds_read_b64_tr_b16 v[42:43], v6 offset:9792
ds_read_b64_tr_b16 v[44:45], v6 offset:13056
ds_read_b64_tr_b16 v[46:47], v6 offset:14144
v_lshlrev_b32 v3, 4, v1
s_lshl_b32 s52, s45, 14
s_lshl_b32 s53, s50, 12
s_add_u32 s52, s52, s53
s_add_u32 s52, s52, 131072
v_add_u32 v9, s52, v3
s_mov_b32 s52, 0xbf317218
s_waitcnt lgkmcnt(6)
v_lshlrev_b32 v52, 16, v32
v_and_b32 v53, 0xffff0000, v32
v_mul_f32 v52, s52, v52
v_mul_f32 v53, s52, v53
v_cvt_pk_bf16_f32 v32, v52, v53
v_lshlrev_b32 v52, 16, v33
v_and_b32 v53, 0xffff0000, v33
v_mul_f32 v52, s52, v52
v_mul_f32 v53, s52, v53
v_cvt_pk_bf16_f32 v33, v52, v53
v_lshlrev_b32 v52, 16, v34
v_and_b32 v53, 0xffff0000, v34
v_mul_f32 v52, s52, v52
v_mul_f32 v53, s52, v53
v_cvt_pk_bf16_f32 v34, v52, v53
v_lshlrev_b32 v52, 16, v35
v_and_b32 v53, 0xffff0000, v35
v_mul_f32 v52, s52, v52
v_mul_f32 v53, s52, v53
v_cvt_pk_bf16_f32 v35, v52, v53
buffer_store_dwordx4 v[32:35], v9, s[36:39], 0 offen offset:0 sc1
s_waitcnt lgkmcnt(4)
v_lshlrev_b32 v52, 16, v36
v_and_b32 v53, 0xffff0000, v36
v_mul_f32 v52, s52, v52
v_mul_f32 v53, s52, v53
v_cvt_pk_bf16_f32 v36, v52, v53
v_lshlrev_b32 v52, 16, v37
v_and_b32 v53, 0xffff0000, v37
v_mul_f32 v52, s52, v52
v_mul_f32 v53, s52, v53
v_cvt_pk_bf16_f32 v37, v52, v53
v_lshlrev_b32 v52, 16, v38
v_and_b32 v53, 0xffff0000, v38
v_mul_f32 v52, s52, v52
v_mul_f32 v53, s52, v53
v_cvt_pk_bf16_f32 v38, v52, v53
v_lshlrev_b32 v52, 16, v39
v_and_b32 v53, 0xffff0000, v39
v_mul_f32 v52, s52, v52
v_mul_f32 v53, s52, v53
v_cvt_pk_bf16_f32 v39, v52, v53
buffer_store_dwordx4 v[36:39], v9, s[36:39], 0 offen offset:1024 sc1
s_waitcnt lgkmcnt(2)
v_lshlrev_b32 v52, 16, v40
v_and_b32 v53, 0xffff0000, v40
v_mul_f32 v52, s52, v52
v_mul_f32 v53, s52, v53
v_cvt_pk_bf16_f32 v40, v52, v53
v_lshlrev_b32 v52, 16, v41
v_and_b32 v53, 0xffff0000, v41
v_mul_f32 v52, s52, v52
v_mul_f32 v53, s52, v53
v_cvt_pk_bf16_f32 v41, v52, v53
v_lshlrev_b32 v52, 16, v42
v_and_b32 v53, 0xffff0000, v42
v_mul_f32 v52, s52, v52
v_mul_f32 v53, s52, v53
v_cvt_pk_bf16_f32 v42, v52, v53
v_lshlrev_b32 v52, 16, v43
v_and_b32 v53, 0xffff0000, v43
v_mul_f32 v52, s52, v52
v_mul_f32 v53, s52, v53
v_cvt_pk_bf16_f32 v43, v52, v53
buffer_store_dwordx4 v[40:43], v9, s[36:39], 0 offen offset:2048 sc1
s_waitcnt lgkmcnt(0)
v_lshlrev_b32 v52, 16, v44
v_and_b32 v53, 0xffff0000, v44
v_mul_f32 v52, s52, v52
v_mul_f32 v53, s52, v53
v_cvt_pk_bf16_f32 v44, v52, v53
v_lshlrev_b32 v52, 16, v45
v_and_b32 v53, 0xffff0000, v45
v_mul_f32 v52, s52, v52
v_mul_f32 v53, s52, v53
v_cvt_pk_bf16_f32 v45, v52, v53
v_lshlrev_b32 v52, 16, v46
v_and_b32 v53, 0xffff0000, v46
v_mul_f32 v52, s52, v52
v_mul_f32 v53, s52, v53
v_cvt_pk_bf16_f32 v46, v52, v53
v_lshlrev_b32 v52, 16, v47
v_and_b32 v53, 0xffff0000, v47
v_mul_f32 v52, s52, v52
v_mul_f32 v53, s52, v53
v_cvt_pk_bf16_f32 v47, v52, v53
buffer_store_dwordx4 v[44:47], v9, s[36:39], 0 offen offset:3072 sc1
K1_END:
s_endpgm
K1_TBLPREP:
s_add_u32 s36, s24, 0x800000
s_addc_u32 s37, s25, 0
s_mov_b32 s38, 0x30000
s_mov_b32 s39, 0x20000
s_cmp_ge_u32 s3, 1
s_cbranch_scc1 K1_EXIT
v_and_b32 v8, 15, v1
v_bfe_u32 v9, v1, 4, 1
v_lshlrev_b32 v10, 2, v9
v_sub_u32 v8, v8, v10
v_and_b32 v10, 0xfffffff4, v8
v_cmp_eq_u32 s[62:63], 0, v10
v_lshrrev_b32 v10, 3, v8
v_lshlrev_b32 v10, 2, v10
v_sub_u32 v8, v8, v10
v_and_b32 v10, 1, v8
v_lshlrev_b32 v10, 4, v10
v_mov_b32 v11, 0x3f80
v_lshlrev_b32 v10, v10, v11
v_cndmask_b32 v10, 0, v10, s[62:63]
v_lshrrev_b32 v8, 1, v8
v_cmp_eq_u32 vcc, 0, v8
v_cndmask_b32 v12, 0, v10, vcc
v_cmp_eq_u32 vcc, 1, v8
v_cndmask_b32 v13, 0, v10, vcc
v_cmp_eq_u32 vcc, 2, v8
v_cndmask_b32 v14, 0, v10, vcc
v_cmp_eq_u32 vcc, 3, v8
v_cndmask_b32 v15, 0, v10, vcc
v_bfe_u32 v8, v1, 3, 2
v_and_b32 v9, 7, v1
v_lshrrev_b32 v10, 1, v8
v_mul_u32_u24 v16, 320, v10
v_lshrrev_b32 v10, 2, v9
v_mul_u32_u24 v10, 160, v10
v_add_u32 v16, v16, v10
v_and_b32 v10, 1, v8
v_lshl_add_u32 v16, v10, 3, v16
v_lshlrev_b32 v19, 4, v10
v_and_b32 v10, 3, v9
v_lshl_add_u32 v16, v10, 1, v16
v_lshl_add_u32 v11, v8, 3, v9
v_lshlrev_b32 v17, 3, v11
v_add_u32 v17, 1280, v17
v_lshlrev_b32 v18, 4, v11
v_add_u32 v18, 1280, v18
v_cmp_gt_u32 vcc, 32, v1
v_cndmask_b32 v12, v16, v12, vcc
v_cndmask_b32 v13, v17, v13, vcc
v_cndmask_b32 v14, v18, v14, vcc
v_cndmask_b32 v15, v19, v15, vcc
v_lshlrev_b32 v9, 4, v1
v_add_u32 v9, 73728, v9
buffer_store_dwordx4 v[12:15], v9, s[36:39], 0 offen sc1
s_endpgm
K1_EXIT:
s_endpgm
.globl standalone__edge_featured_mpnn_mpnn__graph_kernel
.p2align 8
.type standalone__edge_featured_mpnn_mpnn__graph_kernel,@function
standalone__edge_featured_mpnn_mpnn__graph_kernel:
s_cmp_ge_u32 s2, 256
s_cbranch_scc1 K2_EXIT
s_load_dwordx16 s[4:19], s[0:1], 0
s_load_dwordx2 s[20:21], s[0:1], 64
s_load_dwordx2 s[24:25], s[0:1], 80
v_mov_b32 v124, v0
v_and_b32 v1, 63, v0
v_lshrrev_b32 v2, 6, v0
s_nop 0
v_readfirstlane_b32 s3, v2
s_and_b32 s26, s3, 3
s_lshr_b32 s27, s3, 2
s_xor_b32 s95, s3, 0
s_mov_b32 s57, 0
s_mov_b32 s58, 0
s_mov_b32 s55, 0
s_mov_b32 s52, 1.0
s_mov_b32 s53, 1.0
v_lshlrev_b32 v7, 4, v1
s_waitcnt lgkmcnt(0)
s_mov_b32 s40, s4
s_mov_b32 s41, s5
s_mov_b32 s42, 0x271000
s_mov_b32 s43, 0x20000
s_add_u32 s44, s24, 0x800000
s_addc_u32 s45, s25, 0
s_mov_b32 s46, 0x30000
s_mov_b32 s47, 0x20000
s_mov_b32 s28, s24
s_mov_b32 s29, s25
s_mov_b32 s30, 0x200000
s_mov_b32 s31, 0x20000
s_cmp_ge_u32 s3, 4
s_cbranch_scc1 K2_NOX
s_lshl_b32 s60, s2, 13
s_lshl_b32 s61, s3, 11
s_add_u32 s60, s60, s61
s_add_u32 s61, s61, 91392
s_mov_b32 m0, s61
s_nop 0
buffer_load_dwordx4 v7, s[28:31], s60 offen lds
s_add_u32 s60, s60, 1024
s_add_u32 s61, s61, 1024
s_mov_b32 m0, s61
s_nop 0
buffer_load_dwordx4 v7, s[28:31], s60 offen lds
v_lshrrev_b32 v4, 4, v1
v_and_b32 v5, 15, v1
v_xor_b32 v5, v5, v4
v_lshlrev_b32 v5, 4, v5
s_lshl_b32 s60, s3, 2
v_add_u32 v6, s60, v4
v_lshlrev_b32 v6, 8, v6
v_add_u32 v6, s2, v6
v_lshl_add_u32 v6, v6, 8, v5
s_mul_i32 s61, s3, 1040
s_add_u32 s61, s61, 58624
s_mov_b32 m0, s61
s_nop 0
buffer_load_dwordx4 v6, s[40:43], 0 offen lds
s_add_u32 s61, s61, 4160
v_add_u32 v5, 1048576, v6
s_mov_b32 m0, s61
s_nop 0
buffer_load_dwordx4 v5, s[40:43], 0 offen lds
s_cmp_lt_u32 s3, 2
s_cbranch_scc0 K2_TBLD
s_add_u32 s61, s61, 4160
v_add_u32 v4, 2097152, v6
s_mov_b32 m0, s61
s_nop 0
buffer_load_dwordx4 v4, s[40:43], 0 offen lds
s_branch K2_NOX
K2_TBLD:
s_mov_b32 s61, 73728
s_mov_b32 m0, 0
s_nop 0
buffer_load_dwordx4 v7, s[44:47], s61 offen lds
K2_NOX:
v_and_b32 v8, 31, v1
s_lshl_b32 s62, s26, 11
s_add_u32 s62, s62, 65536
s_mov_b32 s94, s62
s_add_u32 s32, s24, 0x200000
s_addc_u32 s33, s25, 0
s_mov_b32 s34, 0x4e8000
s_mov_b32 s35, 0x20000
s_mov_b32 s36, s6
s_mov_b32 s37, s7
s_mov_b32 s38, 0x4e2000
s_mov_b32 s39, 0x20000
v_mov_b32 v16, 0
v_mov_b32 v17, 0
v_mov_b32 v18, 0
v_mov_b32 v19, 0
v_lshlrev_b32 v20, 4, v124
ds_write_b128 v20, v[16:19] offset:1280
ds_write_b128 v20, v[16:19] offset:17664
v_cmp_gt_u32 vcc, 512, v124
s_and_saveexec_b64 s[60:61], vcc
ds_write_b128 v20, v[16:19] offset:34048
s_mov_b64 exec, s[60:61]
v_cmp_gt_u32 vcc, 64, v124
s_and_saveexec_b64 s[60:61], vcc
v_lshlrev_b32 v21, 2, v124
ds_write_b32 v21, v16 offset:1024
s_mov_b64 exec, s[60:61]
s_mul_i32 s92, s27, 10240
s_add_u32 s92, s92, 1280
s_mul_i32 s89, s3, 4192
s_add_u32 s89, s89, 91392
s_lshl_b32 s90, s3, 10
s_add_u32 s90, s90, 42240
s_lshl_b32 s91, s26, 7
v_bfe_u32 v10, v1, 4, 1
v_and_b32 v11, 7, v1
v_xor_b32 v10, v10, v11
v_lshlrev_b32 v123, 4, v10
v_and_b32 v120, 63, v124
v_and_b32 v118, 31, v120
v_lshrrev_b32 v119, 5, v120
v_mul_u32_u24 v119, 160, v119
v_lshl_add_u32 v118, v118, 4, v119
v_add_u32 v118, s92, v118
v_lshrrev_b32 v119, 3, v120
v_lshlrev_b32 v119, 4, v119
v_add_u32 v119, s92, v119
v_lshlrev_b32 v120, 3, v120
v_add_u32 v120, s92, v120
s_cmp_ge_u32 s95, 8
s_cbranch_scc1 K2_NONQ
v_lshrrev_b32 v9, 5, v1
v_and_b32 v10, 15, v8
v_min_u32 v10, 9, v10
v_mul_u32_u24 v11, 1040, v10
v_lshrrev_b32 v12, 4, v8
v_lshl_add_u32 v11, v12, 8, v11
v_add_u32 v11, 58624, v11
v_xor_b32 v13, v9, v12
v_lshl_add_u32 v127, v13, 4, v11
v_xor_b32 v13, 2, v13
v_lshl_add_u32 v126, v13, 4, v11
s_waitcnt vmcnt(0) lgkmcnt(0)
s_barrier
s_lshl_b32 s61, s95, 13
buffer_load_dwordx4 v[64:67], v7, s[44:47], s61 offen offset:0
buffer_load_dwordx4 v[68:71], v7, s[44:47], s61 offen offset:1024
buffer_load_dwordx4 v[72:75], v7, s[44:47], s61 offen offset:2048
buffer_load_dwordx4 v[76:79], v7, s[44:47], s61 offen offset:3072
s_add_u32 s61, s61, 4096
buffer_load_dwordx4 v[80:83], v7, s[44:47], s61 offen offset:0
buffer_load_dwordx4 v[84:87], v7, s[44:47], s61 offen offset:1024
buffer_load_dwordx4 v[88:91], v7, s[44:47], s61 offen offset:2048
buffer_load_dwordx4 v[92:95], v7, s[44:47], s61 offen offset:3072
s_mov_b32 s48, s14
s_mov_b32 s49, s15
s_mov_b32 s50, 0x200
s_mov_b32 s51, 0x20000
s_lshl_b32 s63, s95, 5
v_add_u32 v9, s63, v8
v_lshlrev_b32 v9, 1, v9
buffer_load_ushort v125, v9, s[48:51], 0 offen
buffer_load_dwordx4 v[96:99], v7, s[44:47], s94 offen
buffer_load_dwordx4 v[100:103], v7, s[44:47], s94 offen offset:1024
ds_read_b128 v[32:35], v127 offset:0
ds_read_b128 v[36:39], v126 offset:0
ds_read_b128 v[40:43], v127 offset:64
ds_read_b128 v[44:47], v126 offset:64
ds_read_b128 v[48:51], v127 offset:128
ds_read_b128 v[52:55], v126 offset:128
ds_read_b128 v[56:59], v127 offset:192
ds_read_b128 v[60:63], v126 offset:192
s_waitcnt lgkmcnt(0)
s_barrier
s_waitcnt vmcnt(2)
s_setprio 3
v_mfma_f32_32x32x16_bf16 v[0:15], v[32:35], v[64:67], 0
ds_read_b128 v[32:35], v126 offset:512
v_mfma_f32_32x32x16_bf16 v[0:15], v[36:39], v[68:71], v[0:15]
ds_read_b128 v[36:39], v127 offset:512
v_mfma_f32_32x32x16_bf16 v[0:15], v[40:43], v[72:75], v[0:15]
ds_read_b128 v[40:43], v126 offset:576
v_mfma_f32_32x32x16_bf16 v[0:15], v[44:47], v[76:79], v[0:15]
ds_read_b128 v[44:47], v127 offset:576
v_mfma_f32_32x32x16_bf16 v[0:15], v[48:51], v[80:83], v[0:15]
ds_read_b128 v[48:51], v126 offset:640
v_mfma_f32_32x32x16_bf16 v[0:15], v[52:55], v[84:87], v[0:15]
ds_read_b128 v[52:55], v127 offset:640
v_mfma_f32_32x32x16_bf16 v[0:15], v[56:59], v[88:91], v[0:15]
ds_read_b128 v[56:59], v126 offset:704
v_mfma_f32_32x32x16_bf16 v[0:15], v[60:63], v[92:95], v[0:15]
ds_read_b128 v[60:63], v127 offset:704
s_mov_b32 s60, 0xbfb8aa3b
v_lshlrev_b32 v125, 16, v125
v_mul_f32 v125, s60, v125
s_waitcnt lgkmcnt(0)
s_mov_b32 s60, 0xbfb8aa3b
v_mfma_f32_32x32x16_bf16 v[16:31], v[32:35], v[64:67], 0
v_mfma_f32_32x32x16_bf16 v[16:31], v[36:39], v[68:71], v[16:31]
v_mfma_f32_32x32x16_bf16 v[16:31], v[40:43], v[72:75], v[16:31]
v_mfma_f32_32x32x16_bf16 v[16:31], v[44:47], v[76:79], v[16:31]
v_mfma_f32_32x32x16_bf16 v[16:31], v[48:51], v[80:83], v[16:31]
v_mfma_f32_32x32x16_bf16 v[16:31], v[52:55], v[84:87], v[16:31]
v_mfma_f32_32x32x16_bf16 v[16:31], v[56:59], v[88:91], v[16:31]
v_mfma_f32_32x32x16_bf16 v[16:31], v[60:63], v[92:95], v[16:31]
v_mbcnt_lo_u32_b32 v126, -1, 0
v_mbcnt_hi_u32_b32 v126, -1, v126
s_mul_i32 s61, s95, 2560
s_add_u32 s61, s61, 69120
v_lshlrev_b32 v127, 2, v126
v_add_u32 v127, s61, v127
v_lshlrev_b32 v126, 3, v126
v_add_u32 v126, s61, v126
v_fma_f32 v0, v0, s60, v125
v_fma_f32 v1, v1, s60, v125
v_fma_f32 v2, v2, s60, v125
v_fma_f32 v3, v3, s60, v125
v_fma_f32 v4, v4, s60, v125
v_fma_f32 v5, v5, s60, v125
v_fma_f32 v6, v6, s60, v125
v_fma_f32 v7, v7, s60, v125
v_fma_f32 v8, v8, s60, v125
v_fma_f32 v9, v9, s60, v125
v_fma_f32 v10, v10, s60, v125
v_fma_f32 v11, v11, s60, v125
v_fma_f32 v12, v12, s60, v125
v_fma_f32 v13, v13, s60, v125
v_fma_f32 v14, v14, s60, v125
v_fma_f32 v15, v15, s60, v125
v_cvt_pk_bf16_f32 v32, v0, v1
v_cvt_pk_bf16_f32 v33, v2, v3
v_cvt_pk_bf16_f32 v34, v4, v5
v_cvt_pk_bf16_f32 v36, v8, v9
v_cvt_pk_bf16_f32 v37, v10, v11
v_cvt_pk_bf16_f32 v38, v12, v13
s_nop 3
v_fma_f32 v16, v16, s60, v125
v_fma_f32 v17, v17, s60, v125
v_fma_f32 v18, v18, s60, v125
v_fma_f32 v19, v19, s60, v125
v_fma_f32 v20, v20, s60, v125
v_fma_f32 v21, v21, s60, v125
v_fma_f32 v22, v22, s60, v125
v_fma_f32 v23, v23, s60, v125
v_fma_f32 v24, v24, s60, v125
v_fma_f32 v25, v25, s60, v125
v_fma_f32 v26, v26, s60, v125
v_fma_f32 v27, v27, s60, v125
v_fma_f32 v28, v28, s60, v125
v_fma_f32 v29, v29, s60, v125
v_fma_f32 v30, v30, s60, v125
v_fma_f32 v31, v31, s60, v125
v_cvt_pk_bf16_f32 v40, v16, v17
v_cvt_pk_bf16_f32 v41, v18, v19
v_cvt_pk_bf16_f32 v42, v20, v21
v_cvt_pk_bf16_f32 v44, v24, v25
v_cvt_pk_bf16_f32 v45, v26, v27
v_cvt_pk_bf16_f32 v46, v28, v29
ds_write_b64 v126, v[32:33] offset:0
ds_write_b64 v126, v[36:37] offset:640
ds_write_b64 v126, v[40:41] offset:1280
ds_write_b64 v126, v[44:45] offset:1920
s_mov_b32 exec_hi, 0
ds_write_b32 v127, v34 offset:512
ds_write_b32 v127, v38 offset:1152
ds_write_b32 v127, v42 offset:1792
ds_write_b32 v127, v46 offset:2432
s_mov_b64 exec, -1
v_mov_b32 v24, 1044
v_mov_b32 v25, 1
s_waitcnt lgkmcnt(0)
s_mov_b64 exec, 1
ds_add_u32 v24, v25
s_mov_b64 exec, -1
v_mov_b32 v29, 1024
ds_read_b128 v[24:27], v29
ds_read_b32 v28, v29 offset:16
ds_read_b128 v[112:115], v119 offset:1152
ds_read_b64 v[116:117], v120 offset:0
s_waitcnt lgkmcnt(2)
v_readfirstlane_b32 s76, v24
v_readfirstlane_b32 s77, v25
v_readfirstlane_b32 s78, v26
v_readfirstlane_b32 s79, v27
v_readfirstlane_b32 s80, v28
s_cmp_lt_u32 s27, 2
s_cselect_b32 s81, s76, s78
s_cselect_b32 s82, s77, s79
s_bitcmp1_b32 s27, 0
s_cselect_b32 s59, s82, s81
s_sub_u32 s93, s59, 1
s_bfe_u32 s93, s93, 0x20003
s_add_u32 s93, s93, 1
s_add_u32 s59, s59, 31
s_lshr_b32 s59, s59, 5
s_max_u32 s76, s76, s77
s_max_u32 s78, s78, s79
s_max_u32 s76, s76, s78
s_cmp_gt_u32 s76, 256
s_cselect_b32 s76, 1, 0
s_or_b32 s76, s76, s80
s_cmp_eq_u32 s76, 0
s_cbranch_scc1 K2_NOCHECKQ
s_mov_b32 s57, 1
s_mov_b32 s58, -1
s_mov_b32 s59, 0
v_cmp_gt_u32 vcc, 40, v124
s_and_saveexec_b64 s[60:61], vcc
v_lshlrev_b32 v29, 2, v124
v_mov_b32 v28, 0
ds_write_b32 v29, v28 offset:1088
s_mov_b64 exec, s[60:61]
K2_NOCHECKQ:
s_waitcnt lgkmcnt(0)
s_cmp_lt_i32 s59, 1
s_cbranch_scc1 K2_NOFIRSTQ
v_add_u32 v112, v112, v123
v_add_u32 v113, v113, v123
v_add_u32 v114, v114, v123
v_add_u32 v115, v115, v123
s_mov_b32 m0, s90
s_nop 0
buffer_load_dwordx4 v117, s[36:39], 0 offen lds
s_mov_b32 m0, s89
s_nop 0
buffer_load_dwordx4 v112, s[32:35], s91 offen lds
s_add_u32 m0, s89, 1056
s_nop 0
buffer_load_dwordx4 v113, s[32:35], s91 offen lds
s_add_u32 m0, s89, 2112
s_nop 0
buffer_load_dwordx4 v114, s[32:35], s91 offen lds
s_add_u32 m0, s89, 3168
s_nop 0
buffer_load_dwordx4 v115, s[32:35], s91 offen lds
K2_NOFIRSTQ:
v_mov_b32 v24, 1044
K2_QWQ:
ds_read_b32 v25, v24
s_waitcnt lgkmcnt(0)
v_readfirstlane_b32 s60, v25
s_cmp_lt_u32 s60, 8
s_cbranch_scc1 K2_QWQ
v_mbcnt_lo_u32_b32 v24, -1, 0
v_mbcnt_hi_u32_b32 v24, -1, v24
s_lshl_b32 s60, s26, 3
s_add_u32 s60, s60, s27
s_mul_i32 s60, s60, 640
s_add_u32 s60, s60, 69120
v_lshlrev_b32 v25, 3, v24
v_add_u32 v25, s60, v25
v_and_b32 v24, 31, v24
v_lshlrev_b32 v24, 2, v24
v_add_u32 v24, s60, v24
ds_read_b64 v[88:89], v25 offset:0
ds_read_b32 v90, v24 offset:512
v_mov_b32 v91, 0
ds_read_b64 v[92:93], v25 offset:2560
ds_read_b32 v94, v24 offset:3072
v_mov_b32 v95, 0
v_mbcnt_lo_u32_b32 v28, -1, 0
v_mbcnt_hi_u32_b32 v28, -1, v28
v_and_b32 v24, 31, v28
v_lshrrev_b32 v25, 5, v28
v_and_b32 v26, 3, v24
v_mul_u32_u24 v26, 1056, v26
v_lshrrev_b32 v27, 2, v24
v_lshl_add_u32 v26, v27, 7, v26
v_bfe_u32 v27, v24, 3, 1
v_xor_b32 v27, v27, v25
v_lshl_add_u32 v26, v27, 4, v26
v_add_u32 v121, s89, v26
v_bfe_u32 v27, v24, 3, 1
v_xor_b32 v27, v27, v25
v_lshlrev_b32 v26, 5, v24
v_lshl_add_u32 v26, v27, 4, v26
v_add_u32 v122, s90, v26
v_lshrrev_b32 v26, 4, v24
v_bfe_u32 v27, v24, 1, 2
v_lshl_add_u32 v26, v26, 2, v27
v_bfe_u32 v27, v24, 3, 1
v_cmp_eq_u32 vcc, v27, v25
v_cndmask_b32 v26, -1, v26, vcc
v_and_b32 v27, 1, v24
v_lshlrev_b32 v27, 4, v27
v_mov_b32 v28, 0x3f80
v_lshlrev_b32 v28, v27, v28
v_cmp_eq_u32 vcc, 0, v26
v_cndmask_b32 v104, 0, v28, vcc
v_cmp_eq_u32 vcc, 1, v26
v_cndmask_b32 v105, 0, v28, vcc
v_cmp_eq_u32 vcc, 2, v26
v_cndmask_b32 v106, 0, v28, vcc
v_cmp_eq_u32 vcc, 3, v26
v_cndmask_b32 v107, 0, v28, vcc
v_cmp_eq_u32 vcc, 4, v26
v_cndmask_b32 v108, 0, v28, vcc
v_cmp_eq_u32 vcc, 5, v26
v_cndmask_b32 v109, 0, v28, vcc
v_cmp_eq_u32 vcc, 6, v26
v_cndmask_b32 v110, 0, v28, vcc
v_cmp_eq_u32 vcc, 7, v26
v_cndmask_b32 v111, 0, v28, vcc
v_mov_b32 v32, 0
v_mov_b32 v33, 0
v_mov_b32 v34, 0
v_mov_b32 v35, 0
v_mov_b32 v36, 0
v_mov_b32 v37, 0
v_mov_b32 v38, 0
v_mov_b32 v39, 0
v_mov_b32 v40, 0
v_mov_b32 v41, 0
v_mov_b32 v42, 0
v_mov_b32 v43, 0
v_mov_b32 v44, 0
v_mov_b32 v45, 0
v_mov_b32 v46, 0
v_mov_b32 v47, 0
v_mov_b32 v48, 0
v_mov_b32 v49, 0
v_mov_b32 v50, 0
v_mov_b32 v51, 0
v_mov_b32 v52, 0
v_mov_b32 v53, 0
v_mov_b32 v54, 0
v_mov_b32 v55, 0
v_mov_b32 v56, 0
v_mov_b32 v57, 0
v_mov_b32 v58, 0
v_mov_b32 v59, 0
v_mov_b32 v60, 0
v_mov_b32 v61, 0
v_mov_b32 v62, 0
v_mov_b32 v63, 0
s_waitcnt lgkmcnt(0)
s_branch K2_MAIN
K2_NONQ:
v_and_b32 v24, 511, v124
v_lshrrev_b32 v24, 3, v24
v_mul_u32_u24 v24, 2500, v24
v_and_b32 v25, 7, v124
v_cmp_eq_u32 s[64:65], 7, v25
v_mov_b32 v31, 1
v_mov_b32 v30, 0x3f80
v_and_b32 v26, 511, v124
v_lshlrev_b32 v26, 4, v26
v_add_u32 v26, 91392, v26
s_waitcnt lgkmcnt(0)
s_barrier
ds_read_b128 v[44:47], v26
s_waitcnt lgkmcnt(0)
v_cmp_ne_u32 s[60:61], -1, v44
v_cmp_ne_u32 s[62:63], -1, v46
v_cmp_ne_u32 s[66:67], -1, v45
v_cmp_ne_u32 s[68:69], -1, v47
s_andn2_b64 s[68:69], s[68:69], s[64:65]
v_cmp_lt_u32 vcc, 31, v47
s_and_b64 vcc, vcc, s[64:65]
s_cbranch_vccz K2_NOOVF
s_and_saveexec_b64 s[70:71], vcc
v_mov_b32 v25, 1024
ds_write_b32 v25, v31 offset:16
s_mov_b64 exec, s[70:71]
K2_NOOVF:
v_bfe_u32 v36, v44, 12, 6
v_lshrrev_b32 v37, 18, v44
v_lshlrev_b32 v37, 9, v37
v_and_b32 v38, 0xfff, v44
v_add_u32 v38, v24, v38
v_lshlrev_b32 v38, 5, v38
v_bfe_u32 v39, v46, 12, 6
v_lshrrev_b32 v40, 18, v46
v_lshlrev_b32 v40, 9, v40
v_and_b32 v41, 0xfff, v46
v_add_u32 v41, v24, v41
v_lshlrev_b32 v41, 5, v41
s_or_b64 s[70:71], s[66:67], s[68:69]
s_cmp_eq_u64 s[70:71], 0
s_cbranch_scc0 K2_INS4
s_mov_b64 exec, s[60:61]
v_and_b32 v0, 3, v36
v_lshlrev_b32 v1, 2, v0
ds_add_rtn_u32 v2, v1, v31 offset:1024
v_lshlrev_b32 v1, 2, v36
ds_add_u32 v1, v31 offset:1088
v_and_b32 v3, 0xf0, v1
v_add_u32 v4, 0x100, v3
s_mov_b64 exec, s[62:63]
v_and_b32 v6, 3, v39
v_lshlrev_b32 v7, 2, v6
ds_add_rtn_u32 v12, v7, v31 offset:1024
v_lshlrev_b32 v7, 2, v39
ds_add_u32 v7, v31 offset:1088
v_and_b32 v13, 0xf0, v7
v_add_u32 v14, 0x100, v13
s_mov_b64 exec, s[60:61]
s_waitcnt lgkmcnt(3)
v_cmp_gt_u32 vcc, 256, v2
s_and_b64 s[60:61], exec, vcc
s_mov_b64 exec, s[60:61]
v_lshlrev_b32 v5, 4, v2
v_and_b32 v5, 0x1f0, v5
ds_read_b128 v[8:11], v5 offset:512
v_lshrrev_b32 v2, 5, v2
v_lshl_add_u32 v2, v0, 3, v2
v_mul_u32_u24 v2, 1280, v2
v_lshrrev_b32 v5, 2, v5
v_add_u32 v5, v5, v2
ds_write_b32 v5, v37 offset:2432
s_mov_b64 exec, s[62:63]
s_waitcnt lgkmcnt(3)
v_cmp_gt_u32 vcc, 256, v12
s_and_b64 s[62:63], exec, vcc
s_mov_b64 exec, s[62:63]
v_lshlrev_b32 v15, 4, v12
v_and_b32 v15, 0x1f0, v15
ds_read_b128 v[32:35], v15 offset:512
v_lshrrev_b32 v12, 5, v12
v_lshl_add_u32 v12, v6, 3, v12
v_mul_u32_u24 v12, 1280, v12
v_lshrrev_b32 v15, 2, v15
v_add_u32 v15, v15, v12
ds_write_b32 v15, v40 offset:2432
s_mov_b64 exec, s[60:61]
s_waitcnt lgkmcnt(3)
v_add3_u32 v8, v8, v2, v3
v_add_u32 v9, v9, v2
v_add_u32 v10, v10, v2
v_or_b32 v11, v11, v38
v_xor_b32 v5, 16, v11
ds_write_b16 v8, v30 offset:1792
ds_write2_b32 v9, v3, v4 offset0:0 offset1:64
ds_write2_b32 v10, v11, v5 offset0:1 offset1:3
s_mov_b64 exec, s[62:63]
s_waitcnt lgkmcnt(4)
v_add3_u32 v32, v32, v12, v13
v_add_u32 v33, v33, v12
v_add_u32 v34, v34, v12
v_or_b32 v35, v35, v41
v_xor_b32 v15, 16, v35
ds_write_b16 v32, v30 offset:1792
ds_write2_b32 v33, v13, v14 offset0:0 offset1:64
ds_write2_b32 v34, v35, v15 offset0:1 offset1:3
s_mov_b64 exec, -1
s_branch K2_NOCD
K2_INS4:
v_bfe_u32 v48, v45, 12, 6
v_lshrrev_b32 v49, 18, v45
v_lshlrev_b32 v49, 9, v49
v_and_b32 v50, 0xfff, v45
v_add_u32 v50, v24, v50
v_lshlrev_b32 v50, 5, v50
v_bfe_u32 v51, v47, 12, 6
v_lshrrev_b32 v52, 18, v47
v_lshlrev_b32 v52, 9, v52
v_and_b32 v53, 0xfff, v47
v_add_u32 v53, v24, v53
v_lshlrev_b32 v53, 5, v53
s_mov_b64 exec, s[60:61]
v_and_b32 v0, 3, v36
v_lshlrev_b32 v1, 2, v0
ds_add_rtn_u32 v2, v1, v31 offset:1024
v_lshlrev_b32 v1, 2, v36
ds_add_u32 v1, v31 offset:1088
v_and_b32 v3, 0xf0, v1
v_add_u32 v4, 0x100, v3
s_mov_b64 exec, s[62:63]
v_and_b32 v6, 3, v39
v_lshlrev_b32 v7, 2, v6
ds_add_rtn_u32 v12, v7, v31 offset:1024
v_lshlrev_b32 v7, 2, v39
ds_add_u32 v7, v31 offset:1088
v_and_b32 v13, 0xf0, v7
v_add_u32 v14, 0x100, v13
s_mov_b64 exec, s[66:67]
v_and_b32 v54, 3, v48
v_lshlrev_b32 v55, 2, v54
ds_add_rtn_u32 v56, v55, v31 offset:1024
v_lshlrev_b32 v55, 2, v48
ds_add_u32 v55, v31 offset:1088
v_and_b32 v57, 0xf0, v55
v_add_u32 v58, 0x100, v57
s_mov_b64 exec, s[68:69]
v_and_b32 v64, 3, v51
v_lshlrev_b32 v65, 2, v64
ds_add_rtn_u32 v66, v65, v31 offset:1024
v_lshlrev_b32 v65, 2, v51
ds_add_u32 v65, v31 offset:1088
v_and_b32 v67, 0xf0, v65
v_add_u32 v68, 0x100, v67
s_mov_b64 exec, s[60:61]
s_waitcnt lgkmcnt(7)
v_cmp_gt_u32 vcc, 256, v2
s_and_b64 s[60:61], exec, vcc
s_mov_b64 exec, s[60:61]
v_lshlrev_b32 v5, 4, v2
v_and_b32 v5, 0x1f0, v5
ds_read_b128 v[8:11], v5 offset:512
v_lshrrev_b32 v2, 5, v2
v_lshl_add_u32 v2, v0, 3, v2
v_mul_u32_u24 v2, 1280, v2
v_lshrrev_b32 v5, 2, v5
v_add_u32 v5, v5, v2
ds_write_b32 v5, v37 offset:2432
s_mov_b64 exec, s[62:63]
s_waitcnt lgkmcnt(7)
v_cmp_gt_u32 vcc, 256, v12
s_and_b64 s[62:63], exec, vcc
s_mov_b64 exec, s[62:63]
v_lshlrev_b32 v15, 4, v12
v_and_b32 v15, 0x1f0, v15
ds_read_b128 v[32:35], v15 offset:512
v_lshrrev_b32 v12, 5, v12
v_lshl_add_u32 v12, v6, 3, v12
v_mul_u32_u24 v12, 1280, v12
v_lshrrev_b32 v15, 2, v15
v_add_u32 v15, v15, v12
ds_write_b32 v15, v40 offset:2432
s_mov_b64 exec, s[66:67]
s_waitcnt lgkmcnt(7)
v_cmp_gt_u32 vcc, 256, v56
s_and_b64 s[66:67], exec, vcc
s_mov_b64 exec, s[66:67]
v_lshlrev_b32 v59, 4, v56
v_and_b32 v59, 0x1f0, v59
ds_read_b128 v[60:63], v59 offset:512
v_lshrrev_b32 v56, 5, v56
v_lshl_add_u32 v56, v54, 3, v56
v_mul_u32_u24 v56, 1280, v56
v_lshrrev_b32 v59, 2, v59
v_add_u32 v59, v59, v56
ds_write_b32 v59, v49 offset:2432
s_mov_b64 exec, s[68:69]
s_waitcnt lgkmcnt(7)
v_cmp_gt_u32 vcc, 256, v66
s_and_b64 s[68:69], exec, vcc
s_mov_b64 exec, s[68:69]
v_lshlrev_b32 v69, 4, v66
v_and_b32 v69, 0x1f0, v69
ds_read_b128 v[72:75], v69 offset:512
v_lshrrev_b32 v66, 5, v66
v_lshl_add_u32 v66, v64, 3, v66
v_mul_u32_u24 v66, 1280, v66
v_lshrrev_b32 v69, 2, v69
v_add_u32 v69, v69, v66
ds_write_b32 v69, v52 offset:2432
s_mov_b64 exec, s[60:61]
s_waitcnt lgkmcnt(7)
v_add3_u32 v8, v8, v2, v3
v_add_u32 v9, v9, v2
v_add_u32 v10, v10, v2
v_or_b32 v11, v11, v38
v_xor_b32 v5, 16, v11
ds_write_b16 v8, v30 offset:1792
ds_write2_b32 v9, v3, v4 offset0:0 offset1:64
ds_write2_b32 v10, v11, v5 offset0:1 offset1:3
s_mov_b64 exec, s[62:63]
s_waitcnt lgkmcnt(8)
v_add3_u32 v32, v32, v12, v13
v_add_u32 v33, v33, v12
v_add_u32 v34, v34, v12
v_or_b32 v35, v35, v41
v_xor_b32 v15, 16, v35
ds_write_b16 v32, v30 offset:1792
ds_write2_b32 v33, v13, v14 offset0:0 offset1:64
ds_write2_b32 v34, v35, v15 offset0:1 offset1:3
s_mov_b64 exec, s[66:67]
s_waitcnt lgkmcnt(9)
v_add3_u32 v60, v60, v56, v57
v_add_u32 v61, v61, v56
v_add_u32 v62, v62, v56
v_or_b32 v63, v63, v50
v_xor_b32 v59, 16, v63
ds_write_b16 v60, v30 offset:1792
ds_write2_b32 v61, v57, v58 offset0:0 offset1:64
ds_write2_b32 v62, v63, v59 offset0:1 offset1:3
s_mov_b64 exec, s[68:69]
s_waitcnt lgkmcnt(10)
v_add3_u32 v72, v72, v66, v67
v_add_u32 v73, v73, v66
v_add_u32 v74, v74, v66
v_or_b32 v75, v75, v53
v_xor_b32 v69, 16, v75
ds_write_b16 v72, v30 offset:1792
ds_write2_b32 v73, v67, v68 offset0:0 offset1:64
ds_write2_b32 v74, v75, v69 offset0:1 offset1:3
s_mov_b64 exec, -1
K2_NOCD:
s_waitcnt lgkmcnt(0)
s_barrier
s_setprio 3
v_mov_b32 v29, 1024
ds_read_b128 v[24:27], v29
ds_read_b32 v28, v29 offset:16
ds_read_b128 v[112:115], v119 offset:1152
ds_read_b64 v[116:117], v120 offset:0
s_waitcnt lgkmcnt(2)
v_readfirstlane_b32 s76, v24
v_readfirstlane_b32 s77, v25
v_readfirstlane_b32 s78, v26
v_readfirstlane_b32 s79, v27
v_readfirstlane_b32 s80, v28
s_cmp_lt_u32 s27, 2
s_cselect_b32 s81, s76, s78
s_cselect_b32 s82, s77, s79
s_bitcmp1_b32 s27, 0
s_cselect_b32 s59, s82, s81
s_sub_u32 s93, s59, 1
s_bfe_u32 s93, s93, 0x20003
s_add_u32 s93, s93, 1
s_add_u32 s59, s59, 31
s_lshr_b32 s59, s59, 5
s_max_u32 s76, s76, s77
s_max_u32 s78, s78, s79
s_max_u32 s76, s76, s78
s_cmp_gt_u32 s76, 256
s_cselect_b32 s76, 1, 0
s_or_b32 s76, s76, s80
s_cmp_eq_u32 s76, 0
s_cbranch_scc1 K2_NOCHECKN
s_mov_b32 s57, 1
s_mov_b32 s58, -1
s_mov_b32 s59, 0
v_cmp_gt_u32 vcc, 40, v124
s_and_saveexec_b64 s[60:61], vcc
v_lshlrev_b32 v29, 2, v124
v_mov_b32 v28, 0
ds_write_b32 v29, v28 offset:1088
s_mov_b64 exec, s[60:61]
K2_NOCHECKN:
s_waitcnt lgkmcnt(0)
s_cmp_lt_i32 s59, 1
s_cbranch_scc1 K2_NOFIRSTN
v_add_u32 v112, v112, v123
v_add_u32 v113, v113, v123
v_add_u32 v114, v114, v123
v_add_u32 v115, v115, v123
s_mov_b32 m0, s90
s_nop 0
buffer_load_dwordx4 v117, s[36:39], 0 offen lds
s_mov_b32 m0, s89
s_nop 0
buffer_load_dwordx4 v112, s[32:35], s91 offen lds
s_add_u32 m0, s89, 1056
s_nop 0
buffer_load_dwordx4 v113, s[32:35], s91 offen lds
s_add_u32 m0, s89, 2112
s_nop 0
buffer_load_dwordx4 v114, s[32:35], s91 offen lds
s_add_u32 m0, s89, 3168
s_nop 0
buffer_load_dwordx4 v115, s[32:35], s91 offen lds
K2_NOFIRSTN:
v_mbcnt_lo_u32_b32 v7, -1, 0
v_mbcnt_hi_u32_b32 v7, -1, v7
v_lshlrev_b32 v7, 4, v7
buffer_load_dwordx4 v[96:99], v7, s[44:47], s94 offen
buffer_load_dwordx4 v[100:103], v7, s[44:47], s94 offen offset:1024
v_mov_b32 v24, 1044
K2_QWN:
ds_read_b32 v25, v24
s_waitcnt lgkmcnt(0)
v_readfirstlane_b32 s60, v25
s_cmp_lt_u32 s60, 8
s_cbranch_scc1 K2_QWN
v_mbcnt_lo_u32_b32 v24, -1, 0
v_mbcnt_hi_u32_b32 v24, -1, v24
s_lshl_b32 s60, s26, 3
s_add_u32 s60, s60, s27
s_mul_i32 s60, s60, 640
s_add_u32 s60, s60, 69120
v_lshlrev_b32 v25, 3, v24
v_add_u32 v25, s60, v25
v_and_b32 v24, 31, v24
v_lshlrev_b32 v24, 2, v24
v_add_u32 v24, s60, v24
ds_read_b64 v[88:89], v25 offset:0
ds_read_b32 v90, v24 offset:512
v_mov_b32 v91, 0
ds_read_b64 v[92:93], v25 offset:2560
ds_read_b32 v94, v24 offset:3072
v_mov_b32 v95, 0
v_mbcnt_lo_u32_b32 v28, -1, 0
v_mbcnt_hi_u32_b32 v28, -1, v28
v_and_b32 v24, 31, v28
v_lshrrev_b32 v25, 5, v28
v_and_b32 v26, 3, v24
v_mul_u32_u24 v26, 1056, v26
v_lshrrev_b32 v27, 2, v24
v_lshl_add_u32 v26, v27, 7, v26
v_bfe_u32 v27, v24, 3, 1
v_xor_b32 v27, v27, v25
v_lshl_add_u32 v26, v27, 4, v26
v_add_u32 v121, s89, v26
v_bfe_u32 v27, v24, 3, 1
v_xor_b32 v27, v27, v25
v_lshlrev_b32 v26, 5, v24
v_lshl_add_u32 v26, v27, 4, v26
v_add_u32 v122, s90, v26
v_lshrrev_b32 v26, 4, v24
v_bfe_u32 v27, v24, 1, 2
v_lshl_add_u32 v26, v26, 2, v27
v_bfe_u32 v27, v24, 3, 1
v_cmp_eq_u32 vcc, v27, v25
v_cndmask_b32 v26, -1, v26, vcc
v_and_b32 v27, 1, v24
v_lshlrev_b32 v27, 4, v27
v_mov_b32 v28, 0x3f80
v_lshlrev_b32 v28, v27, v28
v_cmp_eq_u32 vcc, 0, v26
v_cndmask_b32 v104, 0, v28, vcc
v_cmp_eq_u32 vcc, 1, v26
v_cndmask_b32 v105, 0, v28, vcc
v_cmp_eq_u32 vcc, 2, v26
v_cndmask_b32 v106, 0, v28, vcc
v_cmp_eq_u32 vcc, 3, v26
v_cndmask_b32 v107, 0, v28, vcc
v_cmp_eq_u32 vcc, 4, v26
v_cndmask_b32 v108, 0, v28, vcc
v_cmp_eq_u32 vcc, 5, v26
v_cndmask_b32 v109, 0, v28, vcc
v_cmp_eq_u32 vcc, 6, v26
v_cndmask_b32 v110, 0, v28, vcc
v_cmp_eq_u32 vcc, 7, v26
v_cndmask_b32 v111, 0, v28, vcc
v_mov_b32 v32, 0
v_mov_b32 v33, 0
v_mov_b32 v34, 0
v_mov_b32 v35, 0
v_mov_b32 v36, 0
v_mov_b32 v37, 0
v_mov_b32 v38, 0
v_mov_b32 v39, 0
v_mov_b32 v40, 0
v_mov_b32 v41, 0
v_mov_b32 v42, 0
v_mov_b32 v43, 0
v_mov_b32 v44, 0
v_mov_b32 v45, 0
v_mov_b32 v46, 0
v_mov_b32 v47, 0
v_mov_b32 v48, 0
v_mov_b32 v49, 0
v_mov_b32 v50, 0
v_mov_b32 v51, 0
v_mov_b32 v52, 0
v_mov_b32 v53, 0
v_mov_b32 v54, 0
v_mov_b32 v55, 0
v_mov_b32 v56, 0
v_mov_b32 v57, 0
v_mov_b32 v58, 0
v_mov_b32 v59, 0
v_mov_b32 v60, 0
v_mov_b32 v61, 0
v_mov_b32 v62, 0
v_mov_b32 v63, 0
s_waitcnt lgkmcnt(0)
K2_MAIN:
s_cmp_lt_i32 s59, 1
s_cbranch_scc1 K2_DONE
s_cmp_lt_u32 s3, 8
s_cselect_b32 s88, 3, 3
s_cmp_lt_i32 s59, s88
s_cbranch_scc1 K2_LOOPL
K2_LOOPH:
s_setprio 2
s_waitcnt vmcnt(0)
ds_read_b128 v[16:19], v121
ds_read_b128 v[20:23], v121 offset:32
ds_read_b128 v[84:87], v122
ds_read_b128 v[64:67], v116 offset:0
ds_read_b128 v[76:79], v121 offset:64
ds_read_b128 v[80:83], v121 offset:96
ds_read_b128 v[112:115], v119 offset:2432
ds_read_b64 v[116:117], v120 offset:1280
ds_read_b128 v[68:71], v118 offset:512
ds_read_b128 v[72:75], v118 offset:832
s_waitcnt lgkmcnt(6)
v_mfma_f32_32x32x16_bf16 v[0:15], v[16:19], v[104:107], 0
v_mfma_f32_32x32x16_bf16 v[0:15], v[20:23], v[108:111], v[0:15]
v_mfma_f32_32x32x16_bf16 v[0:15], v[84:87], v[96:99], v[0:15]
v_mfma_f32_32x32x16_bf16 v[0:15], v[64:67], v[88:91], v[0:15]
s_waitcnt lgkmcnt(2)
s_cmp_lt_i32 s59, 2
s_cbranch_scc1 K2_NODMA_XH
v_add_u32 v112, v112, v123
v_add_u32 v113, v113, v123
v_add_u32 v114, v114, v123
v_add_u32 v115, v115, v123
s_mov_b32 m0, s90
s_nop 0
buffer_load_dwordx4 v117, s[36:39], 0 offen lds
s_mov_b32 m0, s89
s_nop 0
buffer_load_dwordx4 v112, s[32:35], s91 offen lds
s_add_u32 m0, s89, 1056
s_nop 0
buffer_load_dwordx4 v113, s[32:35], s91 offen lds
s_add_u32 m0, s89, 2112
s_nop 0
buffer_load_dwordx4 v114, s[32:35], s91 offen lds
s_add_u32 m0, s89, 3168
s_nop 0
buffer_load_dwordx4 v115, s[32:35], s91 offen lds
K2_NODMAH:
s_setprio 3
v_exp_f32 v16, v0
v_exp_f32 v17, v1
v_exp_f32 v18, v2
v_exp_f32 v19, v3
v_exp_f32 v20, v4
v_exp_f32 v21, v5
v_exp_f32 v22, v6
v_exp_f32 v23, v7
v_exp_f32 v24, v8
v_exp_f32 v25, v9
v_exp_f32 v26, v10
v_exp_f32 v27, v11
v_exp_f32 v28, v12
v_exp_f32 v29, v13
v_exp_f32 v30, v14
v_exp_f32 v31, v15
v_add_f32 v16, 1.0, v16
v_add_f32 v17, 1.0, v17
v_add_f32 v18, 1.0, v18
v_add_f32 v19, 1.0, v19
v_add_f32 v20, 1.0, v20
v_add_f32 v21, 1.0, v21
v_add_f32 v22, 1.0, v22
v_add_f32 v23, 1.0, v23
v_add_f32 v24, 1.0, v24
v_add_f32 v25, 1.0, v25
v_add_f32 v26, 1.0, v26
v_add_f32 v27, 1.0, v27
v_add_f32 v28, 1.0, v28
v_add_f32 v29, 1.0, v29
v_add_f32 v30, 1.0, v30
v_add_f32 v31, 1.0, v31
v_rcp_f32 v16, v16
v_rcp_f32 v17, v17
v_rcp_f32 v18, v18
v_rcp_f32 v19, v19
v_rcp_f32 v20, v20
v_rcp_f32 v21, v21
v_rcp_f32 v22, v22
v_rcp_f32 v23, v23
v_rcp_f32 v24, v24
v_rcp_f32 v25, v25
v_rcp_f32 v26, v26
v_rcp_f32 v27, v27
v_rcp_f32 v28, v28
v_rcp_f32 v29, v29
v_rcp_f32 v30, v30
v_rcp_f32 v31, v31
s_setprio 2
v_mul_f32 v0, v0, v16
v_mul_f32 v1, v1, v17
v_mul_f32 v2, v2, v18
v_mul_f32 v3, v3, v19
v_mul_f32 v4, v4, v20
v_mul_f32 v5, v5, v21
v_mul_f32 v6, v6, v22
v_mul_f32 v7, v7, v23
v_mul_f32 v8, v8, v24
v_mul_f32 v9, v9, v25
v_mul_f32 v10, v10, v26
v_mul_f32 v11, v11, v27
v_mul_f32 v12, v12, v28
v_mul_f32 v13, v13, v29
v_mul_f32 v14, v14, v30
v_mul_f32 v15, v15, v31
v_cvt_pk_bf16_f32 v16, v0, v1
v_cvt_pk_bf16_f32 v17, v2, v3
v_cvt_pk_bf16_f32 v18, v4, v5
v_cvt_pk_bf16_f32 v19, v6, v7
v_cvt_pk_bf16_f32 v20, v8, v9
v_cvt_pk_bf16_f32 v21, v10, v11
v_cvt_pk_bf16_f32 v22, v12, v13
v_cvt_pk_bf16_f32 v23, v14, v15
s_waitcnt lgkmcnt(0)
s_nop 1
v_mfma_f32_32x32x16_bf16 v[32:47], v[16:19], v[68:71], v[32:47]
v_mfma_f32_32x32x16_bf16 v[32:47], v[20:23], v[72:75], v[32:47]
v_mfma_f32_32x32x16_bf16 v[0:15], v[76:79], v[104:107], 0
v_mfma_f32_32x32x16_bf16 v[0:15], v[80:83], v[108:111], v[0:15]
v_mfma_f32_32x32x16_bf16 v[0:15], v[84:87], v[100:103], v[0:15]
v_mfma_f32_32x32x16_bf16 v[0:15], v[64:67], v[92:95], v[0:15]
s_nop 7
s_nop 3
s_setprio 3
v_exp_f32 v16, v0
v_exp_f32 v17, v1
v_exp_f32 v18, v2
v_exp_f32 v19, v3
v_exp_f32 v20, v4
v_exp_f32 v21, v5
v_exp_f32 v22, v6
v_exp_f32 v23, v7
v_exp_f32 v24, v8
v_exp_f32 v25, v9
v_exp_f32 v26, v10
v_exp_f32 v27, v11
v_exp_f32 v28, v12
v_exp_f32 v29, v13
v_exp_f32 v30, v14
v_exp_f32 v31, v15
v_add_f32 v16, 1.0, v16
v_add_f32 v17, 1.0, v17
v_add_f32 v18, 1.0, v18
v_add_f32 v19, 1.0, v19
v_add_f32 v20, 1.0, v20
v_add_f32 v21, 1.0, v21
v_add_f32 v22, 1.0, v22
v_add_f32 v23, 1.0, v23
v_add_f32 v24, 1.0, v24
v_add_f32 v25, 1.0, v25
v_add_f32 v26, 1.0, v26
v_add_f32 v27, 1.0, v27
v_add_f32 v28, 1.0, v28
v_add_f32 v29, 1.0, v29
v_add_f32 v30, 1.0, v30
v_add_f32 v31, 1.0, v31
v_rcp_f32 v16, v16
v_rcp_f32 v17, v17
v_rcp_f32 v18, v18
v_rcp_f32 v19, v19
v_rcp_f32 v20, v20
v_rcp_f32 v21, v21
v_rcp_f32 v22, v22
v_rcp_f32 v23, v23
v_rcp_f32 v24, v24
v_rcp_f32 v25, v25
v_rcp_f32 v26, v26
v_rcp_f32 v27, v27
v_rcp_f32 v28, v28
v_rcp_f32 v29, v29
v_rcp_f32 v30, v30
v_rcp_f32 v31, v31
s_setprio 2
v_mul_f32 v0, v0, v16
v_mul_f32 v1, v1, v17
v_mul_f32 v2, v2, v18
v_mul_f32 v3, v3, v19
v_mul_f32 v4, v4, v20
v_mul_f32 v5, v5, v21
v_mul_f32 v6, v6, v22
v_mul_f32 v7, v7, v23
v_mul_f32 v8, v8, v24
v_mul_f32 v9, v9, v25
v_mul_f32 v10, v10, v26
v_mul_f32 v11, v11, v27
v_mul_f32 v12, v12, v28
v_mul_f32 v13, v13, v29
v_mul_f32 v14, v14, v30
v_mul_f32 v15, v15, v31
v_cvt_pk_bf16_f32 v16, v0, v1
v_cvt_pk_bf16_f32 v17, v2, v3
v_cvt_pk_bf16_f32 v18, v4, v5
v_cvt_pk_bf16_f32 v19, v6, v7
v_cvt_pk_bf16_f32 v20, v8, v9
v_cvt_pk_bf16_f32 v21, v10, v11
v_cvt_pk_bf16_f32 v22, v12, v13
v_cvt_pk_bf16_f32 v23, v14, v15
s_nop 1
v_mfma_f32_32x32x16_bf16 v[48:63], v[16:19], v[68:71], v[48:63]
v_mfma_f32_32x32x16_bf16 v[48:63], v[20:23], v[72:75], v[48:63]
v_add_u32 v118, 1280, v118
v_add_u32 v119, 1280, v119
v_add_u32 v120, 1280, v120
s_sub_u32 s59, s59, 1
s_cmp_ge_i32 s59, s88
s_cbranch_scc1 K2_LOOPH
s_cmp_lt_i32 s59, 1
s_cbranch_scc1 K2_DONE
K2_LOOPL:
s_setprio 0
s_cmp_eq_u32 s59, 1
s_cselect_b32 s94, s93, 4
s_waitcnt vmcnt(0)
ds_read_b128 v[16:19], v121
ds_read_b128 v[20:23], v121 offset:32
ds_read_b128 v[84:87], v122
ds_read_b128 v[64:67], v116 offset:0
ds_read_b128 v[76:79], v121 offset:64
ds_read_b128 v[80:83], v121 offset:96
ds_read_b128 v[112:115], v119 offset:2432
ds_read_b64 v[116:117], v120 offset:1280
ds_read_b128 v[68:71], v118 offset:512
ds_read_b128 v[72:75], v118 offset:832
s_waitcnt lgkmcnt(6)
v_mfma_f32_32x32x16_bf16 v[0:15], v[16:19], v[104:107], 0
v_mfma_f32_32x32x16_bf16 v[0:15], v[20:23], v[108:111], v[0:15]
v_mfma_f32_32x32x16_bf16 v[0:15], v[84:87], v[96:99], v[0:15]
v_mfma_f32_32x32x16_bf16 v[0:15], v[64:67], v[88:91], v[0:15]
s_waitcnt lgkmcnt(2)
s_cmp_lt_i32 s59, 2
s_cbranch_scc1 K2_NODMA_XL
v_add_u32 v112, v112, v123
v_add_u32 v113, v113, v123
v_add_u32 v114, v114, v123
v_add_u32 v115, v115, v123
s_mov_b32 m0, s90
s_nop 0
buffer_load_dwordx4 v117, s[36:39], 0 offen lds
s_mov_b32 m0, s89
s_nop 0
buffer_load_dwordx4 v112, s[32:35], s91 offen lds
s_add_u32 m0, s89, 1056
s_nop 0
buffer_load_dwordx4 v113, s[32:35], s91 offen lds
s_add_u32 m0, s89, 2112
s_nop 0
buffer_load_dwordx4 v114, s[32:35], s91 offen lds
s_add_u32 m0, s89, 3168
s_nop 0
buffer_load_dwordx4 v115, s[32:35], s91 offen lds
K2_NODMAL:
s_setprio 1
s_cmp_lt_u32 s94, 4
s_cbranch_scc1 K2_SELL0
K2_B3L0:
v_exp_f32 v28, v12
v_exp_f32 v29, v13
v_exp_f32 v30, v14
v_exp_f32 v31, v15
v_add_f32 v28, 1.0, v28
v_add_f32 v29, 1.0, v29
v_add_f32 v30, 1.0, v30
v_add_f32 v31, 1.0, v31
v_rcp_f32 v28, v28
v_rcp_f32 v29, v29
v_rcp_f32 v30, v30
v_rcp_f32 v31, v31
s_nop 0
v_mul_f32 v12, v12, v28
v_mul_f32 v13, v13, v29
v_mul_f32 v14, v14, v30
v_mul_f32 v15, v15, v31
v_cvt_pk_bf16_f32 v22, v12, v13
v_cvt_pk_bf16_f32 v23, v14, v15
K2_B2L0:
v_exp_f32 v24, v8
v_exp_f32 v25, v9
v_exp_f32 v26, v10
v_exp_f32 v27, v11
v_add_f32 v24, 1.0, v24
v_add_f32 v25, 1.0, v25
v_add_f32 v26, 1.0, v26
v_add_f32 v27, 1.0, v27
v_rcp_f32 v24, v24
v_rcp_f32 v25, v25
v_rcp_f32 v26, v26
v_rcp_f32 v27, v27
s_nop 0
v_mul_f32 v8, v8, v24
v_mul_f32 v9, v9, v25
v_mul_f32 v10, v10, v26
v_mul_f32 v11, v11, v27
v_cvt_pk_bf16_f32 v20, v8, v9
v_cvt_pk_bf16_f32 v21, v10, v11
K2_B1L0:
v_exp_f32 v28, v4
v_exp_f32 v29, v5
v_exp_f32 v30, v6
v_exp_f32 v31, v7
v_add_f32 v28, 1.0, v28
v_add_f32 v29, 1.0, v29
v_add_f32 v30, 1.0, v30
v_add_f32 v31, 1.0, v31
v_rcp_f32 v28, v28
v_rcp_f32 v29, v29
v_rcp_f32 v30, v30
v_rcp_f32 v31, v31
s_nop 0
v_mul_f32 v4, v4, v28
v_mul_f32 v5, v5, v29
v_mul_f32 v6, v6, v30
v_mul_f32 v7, v7, v31
v_cvt_pk_bf16_f32 v18, v4, v5
v_cvt_pk_bf16_f32 v19, v6, v7
K2_B0L0:
v_exp_f32 v24, v0
v_exp_f32 v25, v1
v_exp_f32 v26, v2
v_exp_f32 v27, v3
v_add_f32 v24, 1.0, v24
v_add_f32 v25, 1.0, v25
v_add_f32 v26, 1.0, v26
v_add_f32 v27, 1.0, v27
v_rcp_f32 v24, v24
v_rcp_f32 v25, v25
v_rcp_f32 v26, v26
v_rcp_f32 v27, v27
s_nop 0
v_mul_f32 v0, v0, v24
v_mul_f32 v1, v1, v25
v_mul_f32 v2, v2, v26
v_mul_f32 v3, v3, v27
v_cvt_pk_bf16_f32 v16, v0, v1
v_cvt_pk_bf16_f32 v17, v2, v3
s_waitcnt lgkmcnt(0)
s_nop 1
v_mfma_f32_32x32x16_bf16 v[32:47], v[16:19], v[68:71], v[32:47]
v_mfma_f32_32x32x16_bf16 v[32:47], v[20:23], v[72:75], v[32:47]
v_mfma_f32_32x32x16_bf16 v[0:15], v[76:79], v[104:107], 0
v_mfma_f32_32x32x16_bf16 v[0:15], v[80:83], v[108:111], v[0:15]
v_mfma_f32_32x32x16_bf16 v[0:15], v[84:87], v[100:103], v[0:15]
v_mfma_f32_32x32x16_bf16 v[0:15], v[64:67], v[92:95], v[0:15]
s_nop 7
s_nop 3
s_setprio 1
s_cmp_lt_u32 s94, 4
s_cbranch_scc1 K2_SELL1
K2_B3L1:
v_exp_f32 v28, v12
v_exp_f32 v29, v13
v_exp_f32 v30, v14
v_exp_f32 v31, v15
v_add_f32 v28, 1.0, v28
v_add_f32 v29, 1.0, v29
v_add_f32 v30, 1.0, v30
v_add_f32 v31, 1.0, v31
v_rcp_f32 v28, v28
v_rcp_f32 v29, v29
v_rcp_f32 v30, v30
v_rcp_f32 v31, v31
s_nop 0
v_mul_f32 v12, v12, v28
v_mul_f32 v13, v13, v29
v_mul_f32 v14, v14, v30
v_mul_f32 v15, v15, v31
v_cvt_pk_bf16_f32 v22, v12, v13
v_cvt_pk_bf16_f32 v23, v14, v15
K2_B2L1:
v_exp_f32 v24, v8
v_exp_f32 v25, v9
v_exp_f32 v26, v10
v_exp_f32 v27, v11
v_add_f32 v24, 1.0, v24
v_add_f32 v25, 1.0, v25
v_add_f32 v26, 1.0, v26
v_add_f32 v27, 1.0, v27
v_rcp_f32 v24, v24
v_rcp_f32 v25, v25
v_rcp_f32 v26, v26
v_rcp_f32 v27, v27
s_nop 0
v_mul_f32 v8, v8, v24
v_mul_f32 v9, v9, v25
v_mul_f32 v10, v10, v26
v_mul_f32 v11, v11, v27
v_cvt_pk_bf16_f32 v20, v8, v9
v_cvt_pk_bf16_f32 v21, v10, v11
K2_B1L1:
v_exp_f32 v28, v4
v_exp_f32 v29, v5
v_exp_f32 v30, v6
v_exp_f32 v31, v7
v_add_f32 v28, 1.0, v28
v_add_f32 v29, 1.0, v29
v_add_f32 v30, 1.0, v30
v_add_f32 v31, 1.0, v31
v_rcp_f32 v28, v28
v_rcp_f32 v29, v29
v_rcp_f32 v30, v30
v_rcp_f32 v31, v31
s_nop 0
v_mul_f32 v4, v4, v28
v_mul_f32 v5, v5, v29
v_mul_f32 v6, v6, v30
v_mul_f32 v7, v7, v31
v_cvt_pk_bf16_f32 v18, v4, v5
v_cvt_pk_bf16_f32 v19, v6, v7
K2_B0L1:
v_exp_f32 v24, v0
v_exp_f32 v25, v1
v_exp_f32 v26, v2
v_exp_f32 v27, v3
v_add_f32 v24, 1.0, v24
v_add_f32 v25, 1.0, v25
v_add_f32 v26, 1.0, v26
v_add_f32 v27, 1.0, v27
v_rcp_f32 v24, v24
v_rcp_f32 v25, v25
v_rcp_f32 v26, v26
v_rcp_f32 v27, v27
s_nop 0
v_mul_f32 v0, v0, v24
v_mul_f32 v1, v1, v25
v_mul_f32 v2, v2, v26
v_mul_f32 v3, v3, v27
v_cvt_pk_bf16_f32 v16, v0, v1
v_cvt_pk_bf16_f32 v17, v2, v3
s_nop 1
v_mfma_f32_32x32x16_bf16 v[48:63], v[16:19], v[68:71], v[48:63]
v_mfma_f32_32x32x16_bf16 v[48:63], v[20:23], v[72:75], v[48:63]
v_add_u32 v118, 1280, v118
v_add_u32 v119, 1280, v119
v_add_u32 v120, 1280, v120
s_sub_u32 s59, s59, 1
s_cmp_gt_i32 s59, 0
s_cbranch_scc1 K2_LOOPL
K2_DONE:
s_setprio 0
s_cmp_eq_u32 s57, 0
s_cbranch_scc1 K2_EPI
s_add_u32 s58, s58, 1
s_cmp_ge_u32 s58, 625
s_cbranch_scc1 K2_EPI
K2_SLOWFILL:
s_nop 7
s_nop 7
s_waitcnt vmcnt(0) lgkmcnt(0)
s_barrier
v_mov_b32 v16, 0
v_mov_b32 v17, 0
v_mov_b32 v18, 0
v_mov_b32 v19, 0
v_lshlrev_b32 v20, 4, v124
ds_write_b128 v20, v[16:19] offset:1280
ds_write_b128 v20, v[16:19] offset:17664
v_cmp_gt_u32 vcc, 512, v124
s_and_saveexec_b64 s[60:61], vcc
ds_write_b128 v20, v[16:19] offset:34048
s_mov_b64 exec, s[60:61]
v_cmp_gt_u32 vcc, 8, v124
s_and_saveexec_b64 s[60:61], vcc
v_lshlrev_b32 v21, 2, v124
ds_write_b32 v21, v16 offset:1024
s_mov_b64 exec, s[60:61]
s_mov_b32 s40, s10
s_mov_b32 s41, s11
s_mov_b32 s42, 0x9c400
s_mov_b32 s43, 0x20000
s_mov_b32 s44, s8
s_mov_b32 s45, s9
s_mov_b32 s46, 0x9c400
s_mov_b32 s47, 0x20000
s_mul_i32 s60, s58, 256
v_add_u32 v24, s60, v124
v_lshlrev_b32 v25, 2, v24
buffer_load_dword v26, v25, s[40:43], 0 offen
buffer_load_dword v27, v25, s[44:47], 0 offen
s_waitcnt vmcnt(0) lgkmcnt(0)
s_barrier
s_movk_i32 s62, 256
v_cmp_gt_u32 s[60:61], s62, v124
s_mov_b32 s62, 160000
v_cmp_gt_u32 s[64:65], s62, v24
s_and_b64 s[60:61], s[60:61], s[64:65]
v_and_b32 v28, 0xff, v26
v_cmp_eq_u32 s[64:65], s2, v28
s_and_b64 s[60:61], s[60:61], s[64:65]
v_lshrrev_b32 v16, 8, v26
v_lshlrev_b32 v17, 9, v27
v_lshlrev_b32 v18, 5, v24
v_mov_b32 v31, 1
v_mov_b32 v30, 0x3f80
s_cmp_eq_u64 s[60:61], 0
s_cbranch_scc1 K2_INS_SKIPW
s_mov_b64 exec, s[60:61]
v_and_b32 v22, 3, v16
v_lshlrev_b32 v23, 2, v22
ds_add_rtn_u32 v24, v23, v31 offset:1024
v_lshlrev_b32 v23, 2, v16
ds_add_u32 v23, v31 offset:1088
v_and_b32 v25, 0xf0, v23
v_add_u32 v26, 0x100, v25
s_waitcnt lgkmcnt(0)
v_cmp_gt_u32 vcc, 256, v24
s_and_b64 exec, exec, vcc
v_lshlrev_b32 v27, 4, v24
v_and_b32 v27, 0x1f0, v27
ds_read_b128 v[0:3], v27 offset:512
v_lshrrev_b32 v24, 5, v24
v_lshl_add_u32 v24, v22, 3, v24
v_mul_u32_u24 v24, 1280, v24
v_lshrrev_b32 v27, 2, v27
v_add_u32 v27, v27, v24
ds_write_b32 v27, v17 offset:2432
s_waitcnt lgkmcnt(1)
v_add3_u32 v0, v0, v24, v25
v_add_u32 v1, v1, v24
v_add_u32 v2, v2, v24
v_or_b32 v3, v3, v18
v_xor_b32 v4, 16, v3
ds_write_b16 v0, v30 offset:1792
ds_write2_b32 v1, v25, v26 offset0:0 offset1:64
ds_write2_b32 v2, v3, v4 offset0:1 offset1:3
K2_INS_SKIPW:
s_mov_b64 exec, -1
v_and_b32 v120, 63, v124
v_and_b32 v118, 31, v120
v_lshrrev_b32 v119, 5, v120
v_mul_u32_u24 v119, 160, v119
v_lshl_add_u32 v118, v118, 4, v119
v_add_u32 v118, s92, v118
v_lshrrev_b32 v119, 3, v120
v_lshlrev_b32 v119, 4, v119
v_add_u32 v119, s92, v119
v_lshlrev_b32 v120, 3, v120
v_add_u32 v120, s92, v120
s_waitcnt lgkmcnt(0)
s_barrier
v_mov_b32 v29, 1024
ds_read_b128 v[24:27], v29
ds_read_b32 v28, v29 offset:16
ds_read_b128 v[112:115], v119 offset:1152
ds_read_b64 v[116:117], v120 offset:0
s_waitcnt lgkmcnt(2)
v_readfirstlane_b32 s76, v24
v_readfirstlane_b32 s77, v25
v_readfirstlane_b32 s78, v26
v_readfirstlane_b32 s79, v27
v_readfirstlane_b32 s80, v28
s_cmp_lt_u32 s27, 2
s_cselect_b32 s81, s76, s78
s_cselect_b32 s82, s77, s79
s_bitcmp1_b32 s27, 0
s_cselect_b32 s59, s82, s81
s_sub_u32 s93, s59, 1
s_bfe_u32 s93, s93, 0x20003
s_add_u32 s93, s93, 1
s_add_u32 s59, s59, 31
s_lshr_b32 s59, s59, 5
s_waitcnt lgkmcnt(0)
s_cmp_lt_i32 s59, 1
s_cbranch_scc1 K2_NOFIRSTW
v_add_u32 v112, v112, v123
v_add_u32 v113, v113, v123
v_add_u32 v114, v114, v123
v_add_u32 v115, v115, v123
s_mov_b32 m0, s90
s_nop 0
buffer_load_dwordx4 v117, s[36:39], 0 offen lds
s_mov_b32 m0, s89
s_nop 0
buffer_load_dwordx4 v112, s[32:35], s91 offen lds
s_add_u32 m0, s89, 1056
s_nop 0
buffer_load_dwordx4 v113, s[32:35], s91 offen lds
s_add_u32 m0, s89, 2112
s_nop 0
buffer_load_dwordx4 v114, s[32:35], s91 offen lds
s_add_u32 m0, s89, 3168
s_nop 0
buffer_load_dwordx4 v115, s[32:35], s91 offen lds
K2_NOFIRSTW:
s_branch K2_MAIN
K2_EPI:
v_and_b32 v120, 63, v124
v_and_b32 v121, 31, v120
v_lshrrev_b32 v122, 5, v120
v_mov_b32 v127, 0x40000000
s_cmp_ge_u32 s3, 8
s_cbranch_scc1 K2_EPI_NOW2
s_add_u32 s44, s24, 0x800000
s_addc_u32 s45, s25, 0
s_mov_b32 s46, 0x30000
s_mov_b32 s47, 0x20000
s_mov_b32 s48, s18
s_mov_b32 s49, s19
s_mov_b32 s50, 0x100
s_mov_b32 s51, 0x20000
v_lshlrev_b32 v123, 4, v120
s_lshl_b32 s60, s26, 14
s_add_u32 s60, s60, 131072
s_nop 7
s_nop 7
buffer_load_dwordx4 v[0:3], v123, s[44:47], s60 offen offset:0
buffer_load_dwordx4 v[4:7], v123, s[44:47], s60 offen offset:1024
buffer_load_dwordx4 v[8:11], v123, s[44:47], s60 offen offset:2048
buffer_load_dwordx4 v[12:15], v123, s[44:47], s60 offen offset:3072
s_add_u32 s60, s60, 4096
buffer_load_dwordx4 v[16:19], v123, s[44:47], s60 offen offset:0
buffer_load_dwordx4 v[20:23], v123, s[44:47], s60 offen offset:1024
buffer_load_dwordx4 v[24:27], v123, s[44:47], s60 offen offset:2048
buffer_load_dwordx4 v[28:31], v123, s[44:47], s60 offen offset:3072
s_add_u32 s60, s60, 4096
buffer_load_dwordx4 v[64:67], v123, s[44:47], s60 offen offset:0
buffer_load_dwordx4 v[68:71], v123, s[44:47], s60 offen offset:1024
buffer_load_dwordx4 v[72:75], v123, s[44:47], s60 offen offset:2048
buffer_load_dwordx4 v[76:79], v123, s[44:47], s60 offen offset:3072
s_add_u32 s60, s60, 4096
buffer_load_dwordx4 v[80:83], v123, s[44:47], s60 offen offset:0
buffer_load_dwordx4 v[84:87], v123, s[44:47], s60 offen offset:1024
buffer_load_dwordx4 v[88:91], v123, s[44:47], s60 offen offset:2048
buffer_load_dwordx4 v[92:95], v123, s[44:47], s60 offen offset:3072
v_lshlrev_b32 v124, 3, v122
s_lshl_b32 s61, s26, 6
v_add_u32 v124, s61, v124
buffer_load_dwordx2 v[96:97], v124, s[48:51], 0 offen offset:0
buffer_load_dwordx2 v[98:99], v124, s[48:51], 0 offen offset:16
buffer_load_dwordx2 v[100:101], v124, s[48:51], 0 offen offset:32
buffer_load_dwordx2 v[102:103], v124, s[48:51], 0 offen offset:48
K2_EPI_NOW2:
v_mul_u32_u24 v125, 144, v121
v_lshl_add_u32 v125, v122, 3, v125
v_add_u32 v125, s89, v125
s_nop 7
s_nop 1
v_cvt_pk_bf16_f32 v32, v32, v33
v_cvt_pk_bf16_f32 v33, v34, v35
v_cvt_pk_bf16_f32 v34, v36, v37
v_cvt_pk_bf16_f32 v35, v38, v39
v_cvt_pk_bf16_f32 v36, v40, v41
v_cvt_pk_bf16_f32 v37, v42, v43
v_cvt_pk_bf16_f32 v38, v44, v45
v_cvt_pk_bf16_f32 v39, v46, v47
v_cvt_pk_bf16_f32 v40, v48, v49
v_cvt_pk_bf16_f32 v41, v50, v51
v_cvt_pk_bf16_f32 v42, v52, v53
v_cvt_pk_bf16_f32 v43, v54, v55
v_cvt_pk_bf16_f32 v44, v56, v57
v_cvt_pk_bf16_f32 v45, v58, v59
v_cvt_pk_bf16_f32 v46, v60, v61
v_cvt_pk_bf16_f32 v47, v62, v63
v_cmp_gt_u32 vcc, 10, v121
s_and_saveexec_b64 s[62:63], vcc
ds_write_b64 v125, v[32:33] offset:0
ds_write_b64 v125, v[34:35] offset:16
ds_write_b64 v125, v[36:37] offset:32
ds_write_b64 v125, v[38:39] offset:48
ds_write_b64 v125, v[40:41] offset:64
ds_write_b64 v125, v[42:43] offset:80
ds_write_b64 v125, v[44:45] offset:96
ds_write_b64 v125, v[46:47] offset:112
s_mov_b64 exec, s[62:63]
s_cmp_ge_u32 s3, 8
s_cbranch_scc1 K2_EPI_BAR
s_lshl_b32 s60, s27, 5
v_add_u32 v126, s60, v121
v_min_u32 v127, 39, v126
v_and_b32 v125, 3, v127
v_mul_u32_u24 v125, 16768, v125
v_lshrrev_b32 v124, 2, v127
v_mul_u32_u24 v124, 144, v124
v_add_u32 v125, v125, v124
v_lshl_add_u32 v125, v122, 4, v125
v_add_u32 v125, 91392, v125
v_lshlrev_b32 v127, 2, v127
ds_read_b32 v127, v127 offset:1088
s_waitcnt vmcnt(0) lgkmcnt(0)
v_cvt_f32_u32 v127, v127
v_lshlrev_b32 v48, 16, v96
v_and_b32 v49, 0xffff0000, v96
v_lshlrev_b32 v50, 16, v97
v_and_b32 v51, 0xffff0000, v97
v_lshlrev_b32 v52, 16, v98
v_and_b32 v53, 0xffff0000, v98
v_lshlrev_b32 v54, 16, v99
v_and_b32 v55, 0xffff0000, v99
v_lshlrev_b32 v56, 16, v100
v_and_b32 v57, 0xffff0000, v100
v_lshlrev_b32 v58, 16, v101
v_and_b32 v59, 0xffff0000, v101
v_lshlrev_b32 v60, 16, v102
v_and_b32 v61, 0xffff0000, v102
v_lshlrev_b32 v62, 16, v103
v_and_b32 v63, 0xffff0000, v103
v_mul_f32 v48, v48, v127
v_mul_f32 v49, v49, v127
v_mul_f32 v50, v50, v127
v_mul_f32 v51, v51, v127
v_mul_f32 v52, v52, v127
v_mul_f32 v53, v53, v127
v_mul_f32 v54, v54, v127
v_mul_f32 v55, v55, v127
v_mul_f32 v56, v56, v127
v_mul_f32 v57, v57, v127
v_mul_f32 v58, v58, v127
v_mul_f32 v59, v59, v127
v_mul_f32 v60, v60, v127
v_mul_f32 v61, v61, v127
v_mul_f32 v62, v62, v127
v_mul_f32 v63, v63, v127
s_mov_b32 s44, s20
s_mov_b32 s45, s21
s_mov_b32 s46, 0x271000
s_mov_b32 s47, 0x20000
v_lshlrev_b32 v127, 8, v126
v_add_u32 v127, s2, v127
v_lshlrev_b32 v127, 8, v127
v_lshl_add_u32 v127, v122, 3, v127
s_lshl_b32 s61, s26, 6
v_add_u32 v127, s61, v127
v_cmp_gt_u32 vcc, 40, v126
v_mov_b32 v124, 0x40000000
v_cndmask_b32 v127, v124, v127, vcc
K2_EPI_BAR:
s_waitcnt lgkmcnt(0)
s_barrier
s_cmp_ge_u32 s3, 8
s_cbranch_scc1 K2_EPI_END
ds_read_b128 v[96:99], v125 offset:0
ds_read_b128 v[100:103], v125 offset:32
ds_read_b128 v[104:107], v125 offset:64
ds_read_b128 v[108:111], v125 offset:96
ds_read_b128 v[112:115], v125 offset:4192
ds_read_b128 v[116:119], v125 offset:4224
s_waitcnt lgkmcnt(5)
v_mfma_f32_32x32x16_bf16 v[48:63], v[0:3], v[96:99], v[48:63]
ds_read_b128 v[96:99], v125 offset:4256
s_waitcnt lgkmcnt(5)
v_mfma_f32_32x32x16_bf16 v[32:47], v[4:7], v[100:103], 0
ds_read_b128 v[100:103], v125 offset:4288
s_waitcnt lgkmcnt(5)
v_mfma_f32_32x32x16_bf16 v[48:63], v[8:11], v[104:107], v[48:63]
ds_read_b128 v[104:107], v125 offset:8384
s_waitcnt lgkmcnt(5)
v_mfma_f32_32x32x16_bf16 v[32:47], v[12:15], v[108:111], v[32:47]
ds_read_b128 v[108:111], v125 offset:8416
s_waitcnt lgkmcnt(5)
v_mfma_f32_32x32x16_bf16 v[48:63], v[16:19], v[112:115], v[48:63]
ds_read_b128 v[112:115], v125 offset:8448
s_waitcnt lgkmcnt(5)
v_mfma_f32_32x32x16_bf16 v[32:47], v[20:23], v[116:119], v[32:47]
ds_read_b128 v[116:119], v125 offset:8480
s_waitcnt lgkmcnt(5)
v_mfma_f32_32x32x16_bf16 v[48:63], v[24:27], v[96:99], v[48:63]
ds_read_b128 v[96:99], v125 offset:12576
s_waitcnt lgkmcnt(5)
v_mfma_f32_32x32x16_bf16 v[32:47], v[28:31], v[100:103], v[32:47]
ds_read_b128 v[100:103], v125 offset:12608
s_waitcnt lgkmcnt(5)
v_mfma_f32_32x32x16_bf16 v[48:63], v[64:67], v[104:107], v[48:63]
ds_read_b128 v[104:107], v125 offset:12640
s_waitcnt lgkmcnt(5)
v_mfma_f32_32x32x16_bf16 v[32:47], v[68:71], v[108:111], v[32:47]
ds_read_b128 v[108:111], v125 offset:12672
s_waitcnt lgkmcnt(5)
v_mfma_f32_32x32x16_bf16 v[48:63], v[72:75], v[112:115], v[48:63]
s_waitcnt lgkmcnt(4)
v_mfma_f32_32x32x16_bf16 v[32:47], v[76:79], v[116:119], v[32:47]
s_waitcnt lgkmcnt(3)
v_mfma_f32_32x32x16_bf16 v[48:63], v[80:83], v[96:99], v[48:63]
s_waitcnt lgkmcnt(2)
v_mfma_f32_32x32x16_bf16 v[32:47], v[84:87], v[100:103], v[32:47]
s_waitcnt lgkmcnt(1)
v_mfma_f32_32x32x16_bf16 v[48:63], v[88:91], v[104:107], v[48:63]
s_waitcnt lgkmcnt(0)
v_mfma_f32_32x32x16_bf16 v[32:47], v[92:95], v[108:111], v[32:47]
s_nop 7
s_nop 3
v_add_f32 v48, v48, v32
v_add_f32 v49, v49, v33
v_add_f32 v50, v50, v34
v_add_f32 v51, v51, v35
v_add_f32 v52, v52, v36
v_add_f32 v53, v53, v37
v_add_f32 v54, v54, v38
v_add_f32 v55, v55, v39
v_add_f32 v56, v56, v40
v_add_f32 v57, v57, v41
v_add_f32 v58, v58, v42
v_add_f32 v59, v59, v43
v_add_f32 v60, v60, v44
v_add_f32 v61, v61, v45
v_add_f32 v62, v62, v46
v_add_f32 v63, v63, v47
v_cvt_pk_bf16_f32 v48, v48, v49
v_cvt_pk_bf16_f32 v49, v50, v51
v_cvt_pk_bf16_f32 v50, v52, v53
v_cvt_pk_bf16_f32 v51, v54, v55
v_cvt_pk_bf16_f32 v52, v56, v57
v_cvt_pk_bf16_f32 v53, v58, v59
v_cvt_pk_bf16_f32 v54, v60, v61
v_cvt_pk_bf16_f32 v55, v62, v63
buffer_store_dwordx2 v[48:49], v127, s[44:47], 0 offen offset:0
buffer_store_dwordx2 v[50:51], v127, s[44:47], 0 offen offset:16
buffer_store_dwordx2 v[52:53], v127, s[44:47], 0 offen offset:32
buffer_store_dwordx2 v[54:55], v127, s[44:47], 0 offen offset:48
K2_EPI_END:
s_endpgm
K2_NODMA_XH:
s_nop 7
s_nop 3
s_branch K2_NODMAH
K2_NODMA_XL:
s_nop 7
s_nop 3
s_branch K2_NODMAL
K2_SELL0:
s_cmp_eq_u32 s94, 3
s_cbranch_scc1 K2_B2L0
s_cmp_eq_u32 s94, 2
s_cbranch_scc1 K2_B1L0
s_branch K2_B0L0
K2_SELL1:
s_cmp_eq_u32 s94, 3
s_cbranch_scc1 K2_B2L1
s_cmp_eq_u32 s94, 2
s_cbranch_scc1 K2_B1L1
s_branch K2_B0L1
K2_EXIT:
s_endpgm
.section .rodata,"a"
.p2align 6
.amdhsa_kernel mpnn_prep_kernel
  .amdhsa_next_free_vgpr 96
  .amdhsa_next_free_sgpr 102
  .amdhsa_accum_offset 96
  .amdhsa_group_segment_fixed_size 0
  .amdhsa_kernarg_size 88
  .amdhsa_user_sgpr_count 2
  .amdhsa_user_sgpr_kernarg_segment_ptr 1
  .amdhsa_system_sgpr_workgroup_id_x 1
.end_amdhsa_kernel
.p2align 6
.amdhsa_kernel standalone__edge_featured_mpnn_mpnn__graph_kernel
  .amdhsa_next_free_vgpr 128
  .amdhsa_next_free_sgpr 102
  .amdhsa_accum_offset 128
  .amdhsa_group_segment_fixed_size 0
  .amdhsa_kernarg_size 88
  .amdhsa_user_sgpr_count 2
  .amdhsa_user_sgpr_kernarg_segment_ptr 1
  .amdhsa_system_sgpr_workgroup_id_x 1
.end_amdhsa_kernel
```
